```python
import torch

def _softmax(x, axis=-1):
    return torch.softmax(x, dim=axis)
def _gelu(x):
    return torch.nn.functional.gelu(x, approximate="tanh")
def _silu(x):
    return torch.nn.functional.silu(x)
def _sigmoid(x):
    return torch.sigmoid(x)
def _layernorm(x, axis=-1, eps=1e-5):
    m = x.mean(dim=axis, keepdim=True)
    v = x.var(dim=axis, keepdim=True, unbiased=False)
    return (x - m) / torch.sqrt(v + eps)
def _scatter_add(tgt, idx, src, axis=0):
    return tgt.clone().index_add_(axis, idx, src)
def _segment_sum(src, seg, n):
    out = torch.zeros((n,) + src.shape[1:], dtype=src.dtype)
    return out.index_add_(0, seg, src)
def _pad(x, pw):
    flat = tuple(v for pair in reversed(pw) for v in pair)
    return torch.nn.functional.pad(x, flat)

kernel_name = 'standalone__sliding_window_attn__prompt'

def setup_inputs():

    _w = (lambda a: (lambda t: t.to(torch.bfloat16) if t.is_floating_point() else t)(torch.as_tensor(a)))
    B, H, S, D = 1, 32, 2048, 192
    return {
        "q": _w((lambda *s: torch.randn(*s, dtype=torch.bfloat16) * 0.8)(B, H, S, D)),
        "k": _w((lambda *s: torch.randn(*s, dtype=torch.bfloat16) * 0.8)(B, H, S, D)),
        "v": _w((lambda *s: torch.randn(*s, dtype=torch.bfloat16) * 0.05)(B, H, S, D)),
        "window": 256,
    }

def reference(q, k, v, window):
    B, H, S, D = q.shape
    scale = D ** -0.5
    scores = torch.einsum("bhqd,bhkd->bhqk", q, k) * scale
    idx = torch.arange(S)
    mask = (idx[:, None] - idx[None, :] >= 0) & (idx[:, None] - idx[None, :] < window)
    scores = torch.where(mask[None, None], scores, -1e9)
    p = _softmax(scores, axis=-1)
    return torch.einsum("bhqk,bhkd->bhqd", p, v)
```

```asm
; @launch grid=(256,1,1) block=(512,1,1) lds=163840
.amdgcn_target "amdgcn-amd-amdhsa--gfx950"
.text
.globl standalone__sliding_window_attn__prompt_kernel
.p2align 8
.type standalone__sliding_window_attn__prompt_kernel,@function
standalone__sliding_window_attn__prompt_kernel:
    s_cmp_ge_u32 s2, 256
    s_cbranch_scc1 L_end
    s_load_dwordx4 s[4:7], s[0:1], 0
    s_load_dwordx2 s[8:9], s[0:1], 16
    s_load_dwordx2 s[10:11], s[0:1], 32
    s_getpc_b64 s[12:13]
L_pc:
    v_lshlrev_b32 v251, 6, v0
    v_min_u32 v251, L_end-L_pc, v251
    global_load_dword v255, v251, s[12:13]
    v_lshrrev_b32 v253, 6, v0
    v_and_b32 v245, 63, v0
    v_readfirstlane_b32 s14, v253
    s_and_b32 s3, s2, 7
    s_lshl_b32 s3, s3, 13
    s_lshr_b32 s46, s2, 3
    s_and_b32 s52, s46, 7
    s_lshl_b32 s46, s46, 8
    s_add_u32 s3, s3, s46
    v_lshrrev_b32 v253, 3, v245
    v_mul_u32_u24 v238, 384, v253
    v_and_b32 v254, 7, v245
    v_lshrrev_b32 v243, 4, v245
    v_and_b32 v244, 15, v245
    v_xor_b32 v241, v254, v243
    v_lshl_add_u32 v234, v241, 4, v238
    v_xor_b32 v235, 64, v234
    v_add_u32 v235, 2048, v235
    v_mul_u32_u24 v237, 384, v244
    v_lshl_add_u32 v237, v243, 4, v237
    s_lshl_b32 s46, s14, 5
    s_add_u32 s46, s46, s3
    s_mul_i32 s32, s46, 384
    s_add_u32 s33, s32, 6144
    s_lshl_b32 s35, s14, 12
    s_cmp_lt_u32 s14, 4
    s_cselect_b32 s46, 2, 1
    s_cselect_b32 s47, 0, 1
    s_mul_i32 s46, s46, 49152
    s_sub_u32 s34, s32, s46
    s_or_b32 s47, s47, s52
    s_cselect_b32 s34, s34, 0
    s_cselect_b32 s48, 0, 0x40000000
    s_mov_b32 s40, s48
    v_or_b32 v234, s48, v234
    v_or_b32 v235, s48, v235
    s_mov_b32 s22, 25165824
    s_mov_b32 s23, 0x20000
    s_mov_b32 s18, 25165824
    s_mov_b32 s19, 0x20000
    s_mov_b32 s26, 25165824
    s_mov_b32 s27, 0x20000
    s_mov_b32 s30, 25165824
    s_mov_b32 s31, 0x20000
    s_waitcnt lgkmcnt(0)
    s_mov_b32 s20, s6
    s_and_b32 s21, s7, 0xffff
    s_mov_b32 s16, s4
    s_and_b32 s17, s5, 0xffff
    s_add_u32 m0, s35, 0
    s_add_u32 s46, s34, 0
    buffer_load_dwordx4 v234, s[20:23], s46 offen offset:0 lds
    buffer_load_dwordx4 v235, s[20:23], s46 offen offset:1024 lds
    s_add_u32 s46, s34, 4096
    buffer_load_dwordx4 v234, s[20:23], s46 offen offset:2048 lds
    buffer_load_dwordx4 v235, s[20:23], s46 offen offset:3072 lds
    buffer_load_dwordx4 v[144:147], v237, s[16:19], s32 offen offset:0
    buffer_load_dwordx4 v[152:155], v237, s[16:19], s33 offen offset:0
    buffer_load_dwordx4 v[148:151], v237, s[16:19], s32 offen offset:64
    buffer_load_dwordx4 v[156:159], v237, s[16:19], s33 offen offset:64
    s_mov_b32 s24, s8
    s_and_b32 s25, s9, 0xffff
    s_mov_b32 s28, s10
    s_and_b32 s29, s11, 0xffff
    v_lshlrev_b32 v241, 1, v243
    v_xor_b32 v241, v254, v241
    v_lshl_add_u32 v236, v241, 4, v238
    v_or_b32 v236, s40, v236
    v_xor_b32 v241, v254, v253
    v_lshlrev_b32 v241, 4, v241
    v_lshl_add_u32 v240, v253, 7, v241
    v_lshl_add_u32 v238, v254, 4, v238
    v_lshrrev_b32 v241, 1, v244
    v_xor_b32 v241, v241, v243
    v_lshlrev_b32 v241, 4, v241
    v_lshl_add_u32 v224, v244, 7, v241
    v_xor_b32 v225, 64, v224
    v_lshrrev_b32 v241, 1, v243
    v_xor_b32 v241, v241, v254
    v_lshlrev_b32 v241, 4, v241
    v_and_b32 v242, 1, v243
    v_lshl_add_u32 v241, v242, 3, v241
    v_lshl_add_u32 v239, v244, 7, v241
    s_add_u32 s41, s35, 32768
    v_add_u32 v239, s41, v239
    v_add_u32 v240, s41, v240
    v_lshrrev_b32 v241, 2, v245
    v_lshlrev_b32 v226, 7, v241
    v_bfe_u32 v241, v245, 3, 2
    v_lshl_add_u32 v226, v241, 5, v226
    v_and_b32 v241, 3, v245
    v_lshl_add_u32 v226, v241, 3, v226
    v_xor_b32 v227, 32, v226
    v_xor_b32 v228, 64, v226
    v_xor_b32 v229, 96, v226
    v_mov_b32 v220, 0x3f803f80
    v_mov_b32 v221, 0x3f803f80
    v_mov_b32 v222, 0x3f803f80
    v_mov_b32 v223, 0x3f803f80
    s_mov_b32 s54, 0
    s_and_b32 s36, s35, 0x3000
    s_mov_b32 s45, 0x3dd53b95
    v_lshlrev_b32 v241, 2, v243
    v_sub_u32 v241, v244, v241
    v_mov_b32 v249, 0xff800000
    s_cmp_eq_u32 s52, 0
    s_cselect_b32 s53, 0xff800000, 0
    v_mov_b32 v250, s53
    v_mov_b32 v216, s53
    v_mov_b32 v217, s53
    v_mov_b32 v218, s53
    v_mov_b32 v219, s53
    v_mov_b32 v251, v241
    s_barrier
    s_add_u32 m0, s35, 32768
    s_add_u32 s46, s34, 49152
    buffer_load_dwordx4 v234, s[20:23], s46 offen offset:0 lds
    buffer_load_dwordx4 v235, s[20:23], s46 offen offset:1024 lds
    s_add_u32 s46, s34, 53248
    buffer_load_dwordx4 v234, s[20:23], s46 offen offset:2048 lds
    buffer_load_dwordx4 v235, s[20:23], s46 offen offset:3072 lds
    buffer_load_dwordx4 v[160:163], v237, s[16:19], s32 offen offset:128
    buffer_load_dwordx4 v[168:171], v237, s[16:19], s33 offen offset:128
    buffer_load_dwordx4 v[164:167], v237, s[16:19], s32 offen offset:192
    buffer_load_dwordx4 v[172:175], v237, s[16:19], s33 offen offset:192
    s_cmp_ge_u32 s14, 4
    s_cbranch_scc1 L_hi
    v_cmp_gt_i32 s[48:49], 0, v251
    v_cmp_gt_i32 s[50:51], 1, v251
    s_nop 0
    v_cndmask_b32 v64, 0, v249, s[48:49]
    v_cndmask_b32 v48, v249, v250, s[48:49]
    v_cmp_gt_i32 s[48:49], 2, v251
    v_cndmask_b32 v65, 0, v249, s[50:51]
    v_cndmask_b32 v49, v249, v250, s[50:51]
    v_cmp_gt_i32 s[50:51], 3, v251
    v_cndmask_b32 v66, 0, v249, s[48:49]
    v_cndmask_b32 v50, v249, v250, s[48:49]
    v_cmp_gt_i32 s[48:49], 16, v251
    v_cndmask_b32 v67, 0, v249, s[50:51]
    v_cndmask_b32 v51, v249, v250, s[50:51]
    v_cmp_gt_i32 s[50:51], 17, v251
    v_cndmask_b32 v52, v249, v250, s[48:49]
    v_cmp_gt_i32 s[48:49], 18, v251
    v_cndmask_b32 v53, v249, v250, s[50:51]
    v_cmp_gt_i32 s[50:51], 19, v251
    v_cndmask_b32 v54, v249, v250, s[48:49]
    v_cmp_gt_i32 s[48:49], -16, v251
    v_cndmask_b32 v55, v249, v250, s[50:51]
    v_cmp_gt_i32 s[50:51], -15, v251
    v_cndmask_b32 v72, 0, v249, s[48:49]
    v_cmp_gt_i32 s[48:49], -14, v251
    v_cndmask_b32 v73, 0, v249, s[50:51]
    v_cmp_gt_i32 s[50:51], -13, v251
    v_cndmask_b32 v74, 0, v249, s[48:49]
    v_cmp_gt_i32 s[48:49], 0, v251
    v_cndmask_b32 v75, 0, v249, s[50:51]
    v_cmp_gt_i32 s[50:51], 1, v251
    v_cndmask_b32 v76, 0, v249, s[48:49]
    v_cndmask_b32 v60, v249, v250, s[48:49]
    v_cmp_gt_i32 s[48:49], 2, v251
    v_cndmask_b32 v77, 0, v249, s[50:51]
    v_cndmask_b32 v61, v249, v250, s[50:51]
    v_cmp_gt_i32 s[50:51], 3, v251
    v_cndmask_b32 v78, 0, v249, s[48:49]
    v_cndmask_b32 v62, v249, v250, s[48:49]
    v_cndmask_b32 v79, 0, v249, s[50:51]
    v_cndmask_b32 v63, v249, v250, s[50:51]
    s_cmp_le_u32 s36, 8192
    s_cselect_b32 s37, s53, 0
    v_mov_b32 v0, s37
    v_mov_b32 v1, s37
    v_mov_b32 v2, s37
    v_mov_b32 v3, s37
    v_mov_b32 v4, s37
    v_mov_b32 v5, s37
    v_mov_b32 v6, s37
    v_mov_b32 v7, s37
    v_mov_b32 v8, s37
    v_mov_b32 v9, s37
    v_mov_b32 v10, s37
    v_mov_b32 v11, s37
    v_mov_b32 v12, s37
    v_mov_b32 v13, s37
    v_mov_b32 v14, s37
    v_mov_b32 v15, s37
    s_cmp_le_u32 s36, 4096
    s_cselect_b32 s38, s53, 0
    v_mov_b32 v16, s38
    v_mov_b32 v17, s38
    v_mov_b32 v18, s38
    v_mov_b32 v19, s38
    v_mov_b32 v20, s38
    v_mov_b32 v21, s38
    v_mov_b32 v22, s38
    v_mov_b32 v23, s38
    v_mov_b32 v24, s38
    v_mov_b32 v25, s38
    v_mov_b32 v26, s38
    v_mov_b32 v27, s38
    v_mov_b32 v28, s38
    v_mov_b32 v29, s38
    v_mov_b32 v30, s38
    v_mov_b32 v31, s38
    s_cmp_le_u32 s36, 0
    s_cselect_b32 s39, s53, 0
    v_mov_b32 v32, s39
    v_mov_b32 v33, s39
    v_mov_b32 v34, s39
    v_mov_b32 v35, s39
    v_mov_b32 v36, s39
    v_mov_b32 v37, s39
    v_mov_b32 v38, s39
    v_mov_b32 v39, s39
    v_mov_b32 v40, s39
    v_mov_b32 v41, s39
    v_mov_b32 v42, s39
    v_mov_b32 v43, s39
    v_mov_b32 v44, s39
    v_mov_b32 v45, s39
    v_mov_b32 v46, s39
    v_mov_b32 v47, s39
    s_waitcnt vmcnt(12)
    s_barrier
    s_add_u32 s47, s36, 0
    v_add_u32 v230, s47, v224
    v_add_u32 v231, s47, v225
    ds_read_b128 v[192:195], v230 offset:4096
    ds_read_b128 v[196:199], v230 offset:6144
    ds_read_b128 v[200:203], v231 offset:4096
    s_waitcnt vmcnt(11) lgkmcnt(2)
    v_mfma_f32_16x16x32_bf16 v[0:3], v[192:195], v[144:147], v[0:3]
    s_waitcnt vmcnt(10)
    v_mfma_f32_16x16x32_bf16 v[8:11], v[192:195], v[152:155], v[8:11]
    ds_read_b128 v[204:207], v231 offset:6144
    s_add_u32 m0, s35, 65536
    s_add_u32 s46, s34, 128
    buffer_load_dwordx4 v234, s[20:23], s46 offen offset:0 lds
    s_waitcnt lgkmcnt(2)
    v_mfma_f32_16x16x32_bf16 v[4:7], v[196:199], v[144:147], v[4:7]
    v_mfma_f32_16x16x32_bf16 v[12:15], v[196:199], v[152:155], v[12:15]
    ds_read_b128 v[208:211], v230 offset:8192
    s_waitcnt vmcnt(10) lgkmcnt(2)
    v_mfma_f32_16x16x32_bf16 v[0:3], v[200:203], v[148:151], v[0:3]
    s_waitcnt vmcnt(9)
    v_mfma_f32_16x16x32_bf16 v[8:11], v[200:203], v[156:159], v[8:11]
    ds_read_b128 v[212:215], v230 offset:10240
    s_waitcnt lgkmcnt(2)
    v_mfma_f32_16x16x32_bf16 v[4:7], v[204:207], v[148:151], v[4:7]
    v_mfma_f32_16x16x32_bf16 v[12:15], v[204:207], v[156:159], v[12:15]
    ds_read_b128 v[192:195], v231 offset:8192
    buffer_load_dwordx4 v235, s[20:23], s46 offen offset:1024 lds
    s_waitcnt lgkmcnt(2)
    v_mfma_f32_16x16x32_bf16 v[16:19], v[208:211], v[144:147], v[16:19]
    v_mfma_f32_16x16x32_bf16 v[24:27], v[208:211], v[152:155], v[24:27]
    ds_read_b128 v[196:199], v231 offset:10240
    s_waitcnt lgkmcnt(2)
    v_mfma_f32_16x16x32_bf16 v[20:23], v[212:215], v[144:147], v[20:23]
    v_mfma_f32_16x16x32_bf16 v[28:31], v[212:215], v[152:155], v[28:31]
    ds_read_b128 v[200:203], v230 offset:12288
    s_waitcnt lgkmcnt(2)
    v_mfma_f32_16x16x32_bf16 v[16:19], v[192:195], v[148:151], v[16:19]
    v_mfma_f32_16x16x32_bf16 v[24:27], v[192:195], v[156:159], v[24:27]
    ds_read_b128 v[204:207], v230 offset:14336
    s_add_u32 s46, s34, 4224
    buffer_load_dwordx4 v234, s[20:23], s46 offen offset:2048 lds
    s_waitcnt lgkmcnt(2)
    v_mfma_f32_16x16x32_bf16 v[20:23], v[196:199], v[148:151], v[20:23]
    v_mfma_f32_16x16x32_bf16 v[28:31], v[196:199], v[156:159], v[28:31]
    ds_read_b128 v[208:211], v231 offset:12288
    s_waitcnt lgkmcnt(2)
    v_mfma_f32_16x16x32_bf16 v[32:35], v[200:203], v[144:147], v[32:35]
    v_mfma_f32_16x16x32_bf16 v[40:43], v[200:203], v[152:155], v[40:43]
    ds_read_b128 v[212:215], v231 offset:14336
    s_waitcnt lgkmcnt(2)
    v_mfma_f32_16x16x32_bf16 v[36:39], v[204:207], v[144:147], v[36:39]
    v_mfma_f32_16x16x32_bf16 v[44:47], v[204:207], v[152:155], v[44:47]
    ds_read_b128 v[192:195], v230 offset:0
    buffer_load_dwordx4 v235, s[20:23], s46 offen offset:3072 lds
    s_waitcnt lgkmcnt(2)
    v_mfma_f32_16x16x32_bf16 v[32:35], v[208:211], v[148:151], v[32:35]
    v_mfma_f32_16x16x32_bf16 v[40:43], v[208:211], v[156:159], v[40:43]
    ds_read_b128 v[196:199], v230 offset:2048
    s_waitcnt lgkmcnt(2)
    v_mfma_f32_16x16x32_bf16 v[36:39], v[212:215], v[148:151], v[36:39]
    v_mfma_f32_16x16x32_bf16 v[44:47], v[212:215], v[156:159], v[44:47]
    ds_read_b128 v[200:203], v231 offset:0
    s_waitcnt lgkmcnt(2)
    v_mfma_f32_16x16x32_bf16 v[48:51], v[192:195], v[144:147], v[48:51]
    ds_read_b128 v[204:207], v231 offset:2048
    s_waitcnt lgkmcnt(2)
    v_mfma_f32_16x16x32_bf16 v[52:55], v[196:199], v[144:147], v[52:55]
    v_mfma_f32_16x16x32_bf16 v[60:63], v[196:199], v[152:155], v[60:63]
    ds_read_b128 v[208:211], v230 offset:16384
    s_waitcnt lgkmcnt(2)
    v_mfma_f32_16x16x32_bf16 v[48:51], v[200:203], v[148:151], v[48:51]
    ds_read_b128 v[212:215], v230 offset:18432
    s_waitcnt lgkmcnt(2)
    v_mfma_f32_16x16x32_bf16 v[52:55], v[204:207], v[148:151], v[52:55]
    v_mfma_f32_16x16x32_bf16 v[60:63], v[204:207], v[156:159], v[60:63]
    ds_read_b128 v[192:195], v231 offset:16384
    s_waitcnt lgkmcnt(2)
    v_mfma_f32_16x16x32_bf16 v[64:67], v[208:211], v[144:147], v[64:67]
    v_mfma_f32_16x16x32_bf16 v[72:75], v[208:211], v[152:155], v[72:75]
    ds_read_b128 v[196:199], v231 offset:18432
    s_waitcnt lgkmcnt(2)
    v_mfma_f32_16x16x32_bf16 v[76:79], v[212:215], v[152:155], v[76:79]
    s_waitcnt vmcnt(8)
    s_barrier
    v_add_u32 v230, 32768, v224
    v_add_u32 v231, 32768, v225
    ds_read_b128 v[200:203], v230 offset:0
    buffer_load_dwordx4 v[176:179], v237, s[16:19], s32 offen offset:256
    s_waitcnt lgkmcnt(2)
    v_mfma_f32_16x16x32_bf16 v[64:67], v[192:195], v[148:151], v[64:67]
    v_mfma_f32_16x16x32_bf16 v[72:75], v[192:195], v[156:159], v[72:75]
    ds_read_b128 v[204:207], v230 offset:2048
    s_waitcnt lgkmcnt(2)
    v_mfma_f32_16x16x32_bf16 v[76:79], v[196:199], v[156:159], v[76:79]
    ds_read_b128 v[208:211], v231 offset:0
    s_waitcnt lgkmcnt(2)
    v_mfma_f32_16x16x32_bf16 v[80:83], v[200:203], v[144:147], v[216:219]
    v_mfma_f32_16x16x32_bf16 v[88:91], v[200:203], v[152:155], v[216:219]
    ds_read_b128 v[212:215], v231 offset:2048
    buffer_load_dwordx4 v[180:183], v237, s[16:19], s32 offen offset:320
    s_waitcnt lgkmcnt(2)
    v_mfma_f32_16x16x32_bf16 v[84:87], v[204:207], v[144:147], v[216:219]
    v_mfma_f32_16x16x32_bf16 v[92:95], v[204:207], v[152:155], v[216:219]
    ds_read_b128 v[192:195], v230 offset:4096
    s_waitcnt lgkmcnt(2)
    v_mfma_f32_16x16x32_bf16 v[80:83], v[208:211], v[148:151], v[80:83]
    v_mfma_f32_16x16x32_bf16 v[88:91], v[208:211], v[156:159], v[88:91]
    ds_read_b128 v[196:199], v230 offset:6144
    s_waitcnt lgkmcnt(2)
    v_mfma_f32_16x16x32_bf16 v[84:87], v[212:215], v[148:151], v[84:87]
    v_mfma_f32_16x16x32_bf16 v[92:95], v[212:215], v[156:159], v[92:95]
    ds_read_b128 v[200:203], v231 offset:4096
    s_add_u32 m0, s35, 98304
    s_add_u32 s46, s34, 49280
    buffer_load_dwordx4 v234, s[20:23], s46 offen offset:0 lds
    s_waitcnt lgkmcnt(2)
    v_mfma_f32_16x16x32_bf16 v[96:99], v[192:195], v[144:147], v[216:219]
    v_mfma_f32_16x16x32_bf16 v[104:107], v[192:195], v[152:155], v[216:219]
    ds_read_b128 v[204:207], v231 offset:6144
    s_waitcnt lgkmcnt(2)
    v_mfma_f32_16x16x32_bf16 v[100:103], v[196:199], v[144:147], v[216:219]
    v_mfma_f32_16x16x32_bf16 v[108:111], v[196:199], v[152:155], v[216:219]
    ds_read_b128 v[208:211], v230 offset:8192
    s_waitcnt lgkmcnt(2)
    v_mfma_f32_16x16x32_bf16 v[96:99], v[200:203], v[148:151], v[96:99]
    v_mfma_f32_16x16x32_bf16 v[104:107], v[200:203], v[156:159], v[104:107]
    ds_read_b128 v[212:215], v230 offset:10240
    buffer_load_dwordx4 v235, s[20:23], s46 offen offset:1024 lds
    s_waitcnt lgkmcnt(2)
    v_mfma_f32_16x16x32_bf16 v[100:103], v[204:207], v[148:151], v[100:103]
    v_mfma_f32_16x16x32_bf16 v[108:111], v[204:207], v[156:159], v[108:111]
    ds_read_b128 v[192:195], v231 offset:8192
    s_waitcnt lgkmcnt(2)
    v_mfma_f32_16x16x32_bf16 v[112:115], v[208:211], v[144:147], v[216:219]
    v_mfma_f32_16x16x32_bf16 v[120:123], v[208:211], v[152:155], v[216:219]
    ds_read_b128 v[196:199], v231 offset:10240
    s_waitcnt lgkmcnt(2)
    v_mfma_f32_16x16x32_bf16 v[116:119], v[212:215], v[144:147], v[216:219]
    v_mfma_f32_16x16x32_bf16 v[124:127], v[212:215], v[152:155], v[216:219]
    ds_read_b128 v[200:203], v230 offset:12288
    s_add_u32 s46, s34, 53376
    buffer_load_dwordx4 v234, s[20:23], s46 offen offset:2048 lds
    s_waitcnt lgkmcnt(2)
    v_mfma_f32_16x16x32_bf16 v[112:115], v[192:195], v[148:151], v[112:115]
    v_mfma_f32_16x16x32_bf16 v[120:123], v[192:195], v[156:159], v[120:123]
    ds_read_b128 v[204:207], v230 offset:14336
    s_waitcnt lgkmcnt(2)
    v_mfma_f32_16x16x32_bf16 v[116:119], v[196:199], v[148:151], v[116:119]
    v_mfma_f32_16x16x32_bf16 v[124:127], v[196:199], v[156:159], v[124:127]
    ds_read_b128 v[208:211], v231 offset:12288
    s_waitcnt lgkmcnt(2)
    v_mfma_f32_16x16x32_bf16 v[128:131], v[200:203], v[144:147], v[216:219]
    v_mfma_f32_16x16x32_bf16 v[136:139], v[200:203], v[152:155], v[216:219]
    ds_read_b128 v[212:215], v231 offset:14336
    buffer_load_dwordx4 v235, s[20:23], s46 offen offset:3072 lds
    s_waitcnt lgkmcnt(2)
    v_mfma_f32_16x16x32_bf16 v[132:135], v[204:207], v[144:147], v[216:219]
    v_mfma_f32_16x16x32_bf16 v[140:143], v[204:207], v[152:155], v[216:219]
    s_waitcnt vmcnt(6)
    s_barrier
    s_add_u32 s47, s36, 65536
    v_add_u32 v230, s47, v224
    v_add_u32 v231, s47, v225
    ds_read_b128 v[192:195], v230 offset:4096
    buffer_load_dwordx4 v[184:187], v237, s[16:19], s33 offen offset:256
    s_waitcnt lgkmcnt(2)
    v_mfma_f32_16x16x32_bf16 v[128:131], v[208:211], v[148:151], v[128:131]
    v_mfma_f32_16x16x32_bf16 v[136:139], v[208:211], v[156:159], v[136:139]
    ds_read_b128 v[196:199], v230 offset:6144
    s_waitcnt lgkmcnt(2)
    v_mfma_f32_16x16x32_bf16 v[132:135], v[212:215], v[148:151], v[132:135]
    v_mfma_f32_16x16x32_bf16 v[140:143], v[212:215], v[156:159], v[140:143]
    ds_read_b128 v[200:203], v231 offset:4096
    s_waitcnt lgkmcnt(2)
    v_mfma_f32_16x16x32_bf16 v[0:3], v[192:195], v[160:163], v[0:3]
    v_mfma_f32_16x16x32_bf16 v[8:11], v[192:195], v[168:171], v[8:11]
    ds_read_b128 v[204:207], v231 offset:6144
    buffer_load_dwordx4 v[188:191], v237, s[16:19], s33 offen offset:320
    s_waitcnt lgkmcnt(2)
    v_mfma_f32_16x16x32_bf16 v[4:7], v[196:199], v[160:163], v[4:7]
    v_mfma_f32_16x16x32_bf16 v[12:15], v[196:199], v[168:171], v[12:15]
    ds_read_b128 v[208:211], v230 offset:8192
    s_waitcnt lgkmcnt(2)
    v_mfma_f32_16x16x32_bf16 v[0:3], v[200:203], v[164:167], v[0:3]
    v_mfma_f32_16x16x32_bf16 v[8:11], v[200:203], v[172:175], v[8:11]
    ds_read_b128 v[212:215], v230 offset:10240
    s_waitcnt lgkmcnt(2)
    v_mfma_f32_16x16x32_bf16 v[4:7], v[204:207], v[164:167], v[4:7]
    v_mfma_f32_16x16x32_bf16 v[12:15], v[204:207], v[172:175], v[12:15]
    ds_read_b128 v[192:195], v231 offset:8192
    s_add_u32 m0, s35, 131072
    s_add_u32 s46, s34, 256
    buffer_load_dwordx4 v234, s[20:23], s46 offen offset:0 lds
    s_waitcnt lgkmcnt(2)
    v_mfma_f32_16x16x32_bf16 v[16:19], v[208:211], v[160:163], v[16:19]
    v_mfma_f32_16x16x32_bf16 v[24:27], v[208:211], v[168:171], v[24:27]
    ds_read_b128 v[196:199], v231 offset:10240
    s_waitcnt lgkmcnt(2)
    v_mfma_f32_16x16x32_bf16 v[20:23], v[212:215], v[160:163], v[20:23]
    v_mfma_f32_16x16x32_bf16 v[28:31], v[212:215], v[168:171], v[28:31]
    ds_read_b128 v[200:203], v230 offset:12288
    s_waitcnt lgkmcnt(2)
    v_mfma_f32_16x16x32_bf16 v[16:19], v[192:195], v[164:167], v[16:19]
    v_mfma_f32_16x16x32_bf16 v[24:27], v[192:195], v[172:175], v[24:27]
    ds_read_b128 v[204:207], v230 offset:14336
    buffer_load_dwordx4 v235, s[20:23], s46 offen offset:1024 lds
    s_waitcnt lgkmcnt(2)
    v_mfma_f32_16x16x32_bf16 v[20:23], v[196:199], v[164:167], v[20:23]
    v_mfma_f32_16x16x32_bf16 v[28:31], v[196:199], v[172:175], v[28:31]
    ds_read_b128 v[208:211], v231 offset:12288
    s_waitcnt lgkmcnt(2)
    v_mfma_f32_16x16x32_bf16 v[32:35], v[200:203], v[160:163], v[32:35]
    v_mfma_f32_16x16x32_bf16 v[40:43], v[200:203], v[168:171], v[40:43]
    ds_read_b128 v[212:215], v231 offset:14336
    s_waitcnt lgkmcnt(2)
    v_mfma_f32_16x16x32_bf16 v[36:39], v[204:207], v[160:163], v[36:39]
    v_mfma_f32_16x16x32_bf16 v[44:47], v[204:207], v[168:171], v[44:47]
    ds_read_b128 v[192:195], v230 offset:0
    s_add_u32 s46, s34, 4352
    buffer_load_dwordx4 v234, s[20:23], s46 offen offset:2048 lds
    s_waitcnt lgkmcnt(2)
    v_mfma_f32_16x16x32_bf16 v[32:35], v[208:211], v[164:167], v[32:35]
    v_mfma_f32_16x16x32_bf16 v[40:43], v[208:211], v[172:175], v[40:43]
    ds_read_b128 v[196:199], v230 offset:2048
    s_waitcnt lgkmcnt(2)
    v_mfma_f32_16x16x32_bf16 v[36:39], v[212:215], v[164:167], v[36:39]
    v_mfma_f32_16x16x32_bf16 v[44:47], v[212:215], v[172:175], v[44:47]
    ds_read_b128 v[200:203], v231 offset:0
    s_waitcnt lgkmcnt(2)
    v_mfma_f32_16x16x32_bf16 v[48:51], v[192:195], v[160:163], v[48:51]
    ds_read_b128 v[204:207], v231 offset:2048
    buffer_load_dwordx4 v235, s[20:23], s46 offen offset:3072 lds
    s_waitcnt lgkmcnt(2)
    v_mfma_f32_16x16x32_bf16 v[52:55], v[196:199], v[160:163], v[52:55]
    v_mfma_f32_16x16x32_bf16 v[60:63], v[196:199], v[168:171], v[60:63]
    ds_read_b128 v[208:211], v230 offset:16384
    s_waitcnt lgkmcnt(2)
    v_mfma_f32_16x16x32_bf16 v[48:51], v[200:203], v[164:167], v[48:51]
    ds_read_b128 v[212:215], v230 offset:18432
    s_waitcnt lgkmcnt(2)
    v_mfma_f32_16x16x32_bf16 v[52:55], v[204:207], v[164:167], v[52:55]
    v_mfma_f32_16x16x32_bf16 v[60:63], v[204:207], v[172:175], v[60:63]
    ds_read_b128 v[192:195], v231 offset:16384
    s_waitcnt lgkmcnt(2)
    v_mfma_f32_16x16x32_bf16 v[64:67], v[208:211], v[160:163], v[64:67]
    v_mfma_f32_16x16x32_bf16 v[72:75], v[208:211], v[168:171], v[72:75]
    ds_read_b128 v[196:199], v231 offset:18432
    s_waitcnt lgkmcnt(2)
    v_mfma_f32_16x16x32_bf16 v[76:79], v[212:215], v[168:171], v[76:79]
    s_waitcnt vmcnt(6)
    s_barrier
    v_add_u32 v230, 98304, v224
    v_add_u32 v231, 98304, v225
    ds_read_b128 v[200:203], v230 offset:0
    s_add_u32 m0, s35, 0
    s_add_u32 s46, s34, 49408
    buffer_load_dwordx4 v234, s[20:23], s46 offen offset:0 lds
    s_waitcnt lgkmcnt(2)
    v_mfma_f32_16x16x32_bf16 v[64:67], v[192:195], v[164:167], v[64:67]
    v_mfma_f32_16x16x32_bf16 v[72:75], v[192:195], v[172:175], v[72:75]
    ds_read_b128 v[204:207], v230 offset:2048
    s_waitcnt lgkmcnt(2)
    v_mfma_f32_16x16x32_bf16 v[76:79], v[196:199], v[172:175], v[76:79]
    ds_read_b128 v[208:211], v231 offset:0
    s_waitcnt lgkmcnt(2)
    v_mfma_f32_16x16x32_bf16 v[80:83], v[200:203], v[160:163], v[80:83]
    v_mfma_f32_16x16x32_bf16 v[88:91], v[200:203], v[168:171], v[88:91]
    ds_read_b128 v[212:215], v231 offset:2048
    buffer_load_dwordx4 v235, s[20:23], s46 offen offset:1024 lds
    s_waitcnt lgkmcnt(2)
    v_mfma_f32_16x16x32_bf16 v[84:87], v[204:207], v[160:163], v[84:87]
    v_mfma_f32_16x16x32_bf16 v[92:95], v[204:207], v[168:171], v[92:95]
    ds_read_b128 v[192:195], v230 offset:4096
    s_waitcnt lgkmcnt(2)
    v_mfma_f32_16x16x32_bf16 v[80:83], v[208:211], v[164:167], v[80:83]
    v_mfma_f32_16x16x32_bf16 v[88:91], v[208:211], v[172:175], v[88:91]
    ds_read_b128 v[196:199], v230 offset:6144
    s_waitcnt lgkmcnt(2)
    v_mfma_f32_16x16x32_bf16 v[84:87], v[212:215], v[164:167], v[84:87]
    v_mfma_f32_16x16x32_bf16 v[92:95], v[212:215], v[172:175], v[92:95]
    ds_read_b128 v[200:203], v231 offset:4096
    s_add_u32 s46, s34, 53504
    buffer_load_dwordx4 v234, s[20:23], s46 offen offset:2048 lds
    s_waitcnt lgkmcnt(2)
    v_mfma_f32_16x16x32_bf16 v[96:99], v[192:195], v[160:163], v[96:99]
    v_mfma_f32_16x16x32_bf16 v[104:107], v[192:195], v[168:171], v[104:107]
    ds_read_b128 v[204:207], v231 offset:6144
    s_waitcnt lgkmcnt(2)
    v_mfma_f32_16x16x32_bf16 v[100:103], v[196:199], v[160:163], v[100:103]
    v_mfma_f32_16x16x32_bf16 v[108:111], v[196:199], v[168:171], v[108:111]
    ds_read_b128 v[208:211], v230 offset:8192
    s_waitcnt lgkmcnt(2)
    v_mfma_f32_16x16x32_bf16 v[96:99], v[200:203], v[164:167], v[96:99]
    v_mfma_f32_16x16x32_bf16 v[104:107], v[200:203], v[172:175], v[104:107]
    ds_read_b128 v[212:215], v230 offset:10240
    buffer_load_dwordx4 v235, s[20:23], s46 offen offset:3072 lds
    s_waitcnt lgkmcnt(2)
    v_mfma_f32_16x16x32_bf16 v[100:103], v[204:207], v[164:167], v[100:103]
    v_mfma_f32_16x16x32_bf16 v[108:111], v[204:207], v[172:175], v[108:111]
    ds_read_b128 v[192:195], v231 offset:8192
    s_waitcnt lgkmcnt(2)
    v_mfma_f32_16x16x32_bf16 v[112:115], v[208:211], v[160:163], v[112:115]
    v_mfma_f32_16x16x32_bf16 v[120:123], v[208:211], v[168:171], v[120:123]
    ds_read_b128 v[196:199], v231 offset:10240
    s_waitcnt lgkmcnt(2)
    v_mfma_f32_16x16x32_bf16 v[116:119], v[212:215], v[160:163], v[116:119]
    v_mfma_f32_16x16x32_bf16 v[124:127], v[212:215], v[168:171], v[124:127]
    ds_read_b128 v[200:203], v230 offset:12288
    s_waitcnt lgkmcnt(2)
    v_mfma_f32_16x16x32_bf16 v[112:115], v[192:195], v[164:167], v[112:115]
    v_mfma_f32_16x16x32_bf16 v[120:123], v[192:195], v[172:175], v[120:123]
    ds_read_b128 v[204:207], v230 offset:14336
    s_waitcnt lgkmcnt(2)
    v_mfma_f32_16x16x32_bf16 v[116:119], v[196:199], v[164:167], v[116:119]
    v_mfma_f32_16x16x32_bf16 v[124:127], v[196:199], v[172:175], v[124:127]
    ds_read_b128 v[208:211], v231 offset:12288
    s_waitcnt lgkmcnt(2)
    v_mfma_f32_16x16x32_bf16 v[128:131], v[200:203], v[160:163], v[128:131]
    v_mfma_f32_16x16x32_bf16 v[136:139], v[200:203], v[168:171], v[136:139]
    ds_read_b128 v[212:215], v231 offset:14336
    s_waitcnt lgkmcnt(2)
    v_mfma_f32_16x16x32_bf16 v[132:135], v[204:207], v[160:163], v[132:135]
    v_mfma_f32_16x16x32_bf16 v[140:143], v[204:207], v[168:171], v[140:143]
    s_waitcnt vmcnt(4)
    s_barrier
    s_add_u32 s47, s36, 131072
    v_add_u32 v230, s47, v224
    v_add_u32 v231, s47, v225
    ds_read_b128 v[192:195], v230 offset:4096
    s_add_u32 m0, s35, 32768
    s_add_u32 s46, s34, 0
    buffer_load_dwordx4 v236, s[24:27], s46 offen offset:0 lds
    s_waitcnt lgkmcnt(2)
    v_mfma_f32_16x16x32_bf16 v[128:131], v[208:211], v[164:167], v[128:131]
    v_mfma_f32_16x16x32_bf16 v[136:139], v[208:211], v[172:175], v[136:139]
    ds_read_b128 v[196:199], v230 offset:6144
    s_waitcnt lgkmcnt(2)
    v_mfma_f32_16x16x32_bf16 v[132:135], v[212:215], v[164:167], v[132:135]
    v_mfma_f32_16x16x32_bf16 v[140:143], v[212:215], v[172:175], v[140:143]
    ds_read_b128 v[200:203], v231 offset:4096
    s_waitcnt lgkmcnt(2)
    v_mfma_f32_16x16x32_bf16 v[0:3], v[192:195], v[176:179], v[0:3]
    v_mfma_f32_16x16x32_bf16 v[8:11], v[192:195], v[184:187], v[8:11]
    ds_read_b128 v[204:207], v231 offset:6144
    s_add_u32 s46, s34, 2048
    buffer_load_dwordx4 v236, s[24:27], s46 offen offset:1024 lds
    s_waitcnt lgkmcnt(2)
    v_mfma_f32_16x16x32_bf16 v[4:7], v[196:199], v[176:179], v[4:7]
    v_mfma_f32_16x16x32_bf16 v[12:15], v[196:199], v[184:187], v[12:15]
    ds_read_b128 v[208:211], v230 offset:8192
    s_waitcnt lgkmcnt(2)
    v_mfma_f32_16x16x32_bf16 v[0:3], v[200:203], v[180:183], v[0:3]
    v_mfma_f32_16x16x32_bf16 v[8:11], v[200:203], v[188:191], v[8:11]
    ds_read_b128 v[212:215], v230 offset:10240
    s_waitcnt lgkmcnt(2)
    v_mfma_f32_16x16x32_bf16 v[4:7], v[204:207], v[180:183], v[4:7]
    v_mfma_f32_16x16x32_bf16 v[12:15], v[204:207], v[188:191], v[12:15]
    ds_read_b128 v[192:195], v231 offset:8192
    s_add_u32 s46, s34, 4096
    buffer_load_dwordx4 v236, s[24:27], s46 offen offset:2048 lds
    s_waitcnt lgkmcnt(2)
    v_mfma_f32_16x16x32_bf16 v[16:19], v[208:211], v[176:179], v[16:19]
    v_mfma_f32_16x16x32_bf16 v[24:27], v[208:211], v[184:187], v[24:27]
    ds_read_b128 v[196:199], v231 offset:10240
    s_waitcnt lgkmcnt(2)
    v_mfma_f32_16x16x32_bf16 v[20:23], v[212:215], v[176:179], v[20:23]
    v_max3_f32 v241, v0, v1, v2
    v_max3_f32 v242, v8, v9, v10
    v_mfma_f32_16x16x32_bf16 v[28:31], v[212:215], v[184:187], v[28:31]
    ds_read_b128 v[200:203], v230 offset:12288
    v_max3_f32 v241, v241, v3, v4
    v_max3_f32 v242, v242, v11, v12
    s_waitcnt lgkmcnt(2)
    v_mfma_f32_16x16x32_bf16 v[16:19], v[192:195], v[180:183], v[16:19]
    v_max3_f32 v241, v241, v5, v6
    v_max3_f32 v242, v242, v13, v14
    v_mfma_f32_16x16x32_bf16 v[24:27], v[192:195], v[188:191], v[24:27]
    ds_read_b128 v[204:207], v230 offset:14336
    s_add_u32 s46, s34, 6144
    buffer_load_dwordx4 v236, s[24:27], s46 offen offset:3072 lds
    v_max_f32 v241, v241, v7
    v_max_f32 v242, v242, v15
    s_waitcnt lgkmcnt(2)
    v_mfma_f32_16x16x32_bf16 v[20:23], v[196:199], v[180:183], v[20:23]
    v_mfma_f32_16x16x32_bf16 v[28:31], v[196:199], v[188:191], v[28:31]
    ds_read_b128 v[208:211], v231 offset:12288
    s_waitcnt lgkmcnt(2)
    v_mfma_f32_16x16x32_bf16 v[32:35], v[200:203], v[176:179], v[32:35]
    v_mfma_f32_16x16x32_bf16 v[40:43], v[200:203], v[184:187], v[40:43]
    ds_read_b128 v[212:215], v231 offset:14336
    s_waitcnt lgkmcnt(2)
    v_mfma_f32_16x16x32_bf16 v[36:39], v[204:207], v[176:179], v[36:39]
    v_max3_f32 v241, v241, v16, v17
    v_max3_f32 v242, v242, v24, v25
    v_mfma_f32_16x16x32_bf16 v[44:47], v[204:207], v[184:187], v[44:47]
    ds_read_b128 v[192:195], v230 offset:0
    v_max3_f32 v241, v241, v18, v19
    v_max3_f32 v242, v242, v26, v27
    s_waitcnt lgkmcnt(2)
    v_mfma_f32_16x16x32_bf16 v[32:35], v[208:211], v[180:183], v[32:35]
    v_max3_f32 v241, v241, v20, v21
    v_max3_f32 v242, v242, v28, v29
    v_mfma_f32_16x16x32_bf16 v[40:43], v[208:211], v[188:191], v[40:43]
    ds_read_b128 v[196:199], v230 offset:2048
    v_max3_f32 v241, v241, v22, v23
    v_max3_f32 v242, v242, v30, v31
    s_waitcnt lgkmcnt(2)
    v_mfma_f32_16x16x32_bf16 v[36:39], v[212:215], v[180:183], v[36:39]
    v_mfma_f32_16x16x32_bf16 v[44:47], v[212:215], v[188:191], v[44:47]
    ds_read_b128 v[200:203], v231 offset:0
    s_waitcnt lgkmcnt(2)
    v_mfma_f32_16x16x32_bf16 v[48:51], v[192:195], v[176:179], v[48:51]
    ds_read_b128 v[204:207], v231 offset:2048
    s_waitcnt lgkmcnt(2)
    v_mfma_f32_16x16x32_bf16 v[52:55], v[196:199], v[176:179], v[52:55]
    v_max3_f32 v241, v241, v32, v33
    v_max3_f32 v242, v242, v40, v41
    v_mfma_f32_16x16x32_bf16 v[60:63], v[196:199], v[184:187], v[60:63]
    ds_read_b128 v[208:211], v230 offset:16384
    v_max3_f32 v241, v241, v34, v35
    v_max3_f32 v242, v242, v42, v43
    s_waitcnt lgkmcnt(2)
    v_mfma_f32_16x16x32_bf16 v[48:51], v[200:203], v[180:183], v[48:51]
    v_max3_f32 v241, v241, v36, v37
    v_max3_f32 v242, v242, v44, v45
    ds_read_b128 v[212:215], v230 offset:18432
    v_max3_f32 v241, v241, v38, v39
    v_max3_f32 v242, v242, v46, v47
    s_waitcnt lgkmcnt(2)
    v_mfma_f32_16x16x32_bf16 v[52:55], v[204:207], v[180:183], v[52:55]
    v_mfma_f32_16x16x32_bf16 v[60:63], v[204:207], v[188:191], v[60:63]
    ds_read_b128 v[192:195], v231 offset:16384
    s_waitcnt lgkmcnt(2)
    v_mfma_f32_16x16x32_bf16 v[64:67], v[208:211], v[176:179], v[64:67]
    v_mfma_f32_16x16x32_bf16 v[72:75], v[208:211], v[184:187], v[72:75]
    ds_read_b128 v[196:199], v231 offset:18432
    s_waitcnt lgkmcnt(2)
    v_mfma_f32_16x16x32_bf16 v[76:79], v[212:215], v[184:187], v[76:79]
    v_max3_f32 v241, v241, v48, v49
    s_waitcnt vmcnt(4)
    s_barrier
    v_add_u32 v230, 0, v224
    v_add_u32 v231, 0, v225
    ds_read_b128 v[200:203], v230 offset:0
    s_add_u32 m0, s35, 65536
    s_add_u32 s46, s34, 128
    buffer_load_dwordx4 v236, s[24:27], s46 offen offset:0 lds
    v_max3_f32 v242, v242, v60, v61
    s_waitcnt lgkmcnt(2)
    v_mfma_f32_16x16x32_bf16 v[64:67], v[192:195], v[180:183], v[64:67]
    v_max3_f32 v241, v241, v50, v51
    v_max3_f32 v242, v242, v62, v63
    v_mfma_f32_16x16x32_bf16 v[72:75], v[192:195], v[188:191], v[72:75]
    ds_read_b128 v[204:207], v230 offset:2048
    v_max3_f32 v241, v241, v52, v53
    v_max3_f32 v241, v241, v54, v55
    s_waitcnt lgkmcnt(2)
    v_mfma_f32_16x16x32_bf16 v[76:79], v[196:199], v[188:191], v[76:79]
    ds_read_b128 v[208:211], v231 offset:0
    s_waitcnt lgkmcnt(2)
    v_mfma_f32_16x16x32_bf16 v[80:83], v[200:203], v[176:179], v[80:83]
    v_mfma_f32_16x16x32_bf16 v[88:91], v[200:203], v[184:187], v[88:91]
    ds_read_b128 v[212:215], v231 offset:2048
    s_add_u32 s46, s34, 2176
    buffer_load_dwordx4 v236, s[24:27], s46 offen offset:1024 lds
    s_waitcnt lgkmcnt(2)
    v_mfma_f32_16x16x32_bf16 v[84:87], v[204:207], v[176:179], v[84:87]
    v_max3_f32 v241, v241, v64, v65
    v_max3_f32 v242, v242, v72, v73
    v_mfma_f32_16x16x32_bf16 v[92:95], v[204:207], v[184:187], v[92:95]
    ds_read_b128 v[192:195], v230 offset:4096
    v_max3_f32 v241, v241, v66, v67
    s_waitcnt lgkmcnt(2)
    v_mfma_f32_16x16x32_bf16 v[80:83], v[208:211], v[180:183], v[80:83]
    v_max3_f32 v242, v242, v74, v75
    v_max3_f32 v242, v242, v76, v77
    v_mfma_f32_16x16x32_bf16 v[88:91], v[208:211], v[188:191], v[88:91]
    ds_read_b128 v[196:199], v230 offset:6144
    v_max3_f32 v242, v242, v78, v79
    s_waitcnt lgkmcnt(2)
    v_mfma_f32_16x16x32_bf16 v[84:87], v[212:215], v[180:183], v[84:87]
    v_permlane32_swap_b32 v241, v242
    v_max_f32 v241, v241, v242
    v_mov_b32 v242, v241
    v_mfma_f32_16x16x32_bf16 v[92:95], v[212:215], v[188:191], v[92:95]
    ds_read_b128 v[200:203], v231 offset:4096
    s_add_u32 s46, s34, 4224
    buffer_load_dwordx4 v236, s[24:27], s46 offen offset:2048 lds
    v_permlane16_swap_b32 v241, v242
    v_max_f32 v241, v241, v242
    v_mov_b32 v242, v241
    s_waitcnt lgkmcnt(2)
    v_mfma_f32_16x16x32_bf16 v[96:99], v[192:195], v[176:179], v[96:99]
    v_permlane32_swap_b32 v241, v242
    v_mul_f32 v245, s45, v241
    v_mul_f32 v247, s45, v241
    v_mfma_f32_16x16x32_bf16 v[104:107], v[192:195], v[184:187], v[104:107]
    ds_read_b128 v[204:207], v231 offset:6144
    v_mul_f32 v246, s45, v242
    v_mul_f32 v248, s45, v242
    s_waitcnt lgkmcnt(2)
    v_mfma_f32_16x16x32_bf16 v[100:103], v[196:199], v[176:179], v[100:103]
    v_max3_f32 v243, v80, v81, v82
    v_max3_f32 v244, v88, v89, v90
    v_max3_f32 v243, v243, v83, v84
    v_max3_f32 v244, v244, v91, v92
    v_fma_f32 v0, v0, s45, -v245
    v_fma_f32 v1, v1, s45, -v245
    v_mfma_f32_16x16x32_bf16 v[108:111], v[196:199], v[184:187], v[108:111]
    ds_read_b128 v[208:211], v230 offset:8192
    v_exp_f32 v0, v0
    v_exp_f32 v1, v1
    v_fma_f32 v2, v2, s45, -v245
    v_fma_f32 v3, v3, s45, -v245
    v_exp_f32 v2, v2
    s_waitcnt lgkmcnt(2)
    v_mfma_f32_16x16x32_bf16 v[96:99], v[200:203], v[180:183], v[96:99]
    v_max3_f32 v243, v243, v85, v86
    v_max3_f32 v244, v244, v93, v94
    v_max_f32 v243, v243, v87
    v_max_f32 v244, v244, v95
    v_exp_f32 v3, v3
    v_cvt_pk_bf16_f32 v0, v0, v1
    v_fma_f32 v4, v4, s45, -v245
    v_mfma_f32_16x16x32_bf16 v[104:107], v[200:203], v[188:191], v[104:107]
    ds_read_b128 v[212:215], v230 offset:10240
    s_add_u32 s46, s34, 6272
    buffer_load_dwordx4 v236, s[24:27], s46 offen offset:3072 lds
    v_fma_f32 v5, v5, s45, -v245
    v_exp_f32 v4, v4
    v_exp_f32 v5, v5
    v_cvt_pk_bf16_f32 v1, v2, v3
    v_fma_f32 v6, v6, s45, -v245
    s_waitcnt lgkmcnt(2)
    v_mfma_f32_16x16x32_bf16 v[100:103], v[204:207], v[180:183], v[100:103]
    v_fma_f32 v7, v7, s45, -v245
    v_exp_f32 v6, v6
    v_exp_f32 v7, v7
    v_cvt_pk_bf16_f32 v2, v4, v5
    v_fma_f32 v8, v8, s45, -v246
    v_fma_f32 v9, v9, s45, -v246
    v_mfma_f32_16x16x32_bf16 v[108:111], v[204:207], v[188:191], v[108:111]
    ds_read_b128 v[192:195], v231 offset:8192
    v_exp_f32 v8, v8
    v_exp_f32 v9, v9
    v_cvt_pk_bf16_f32 v3, v6, v7
    v_fma_f32 v10, v10, s45, -v246
    v_fma_f32 v11, v11, s45, -v246
    s_waitcnt lgkmcnt(2)
    v_mfma_f32_16x16x32_bf16 v[112:115], v[208:211], v[176:179], v[112:115]
    v_exp_f32 v10, v10
    v_exp_f32 v11, v11
    v_cvt_pk_bf16_f32 v4, v8, v9
    v_fma_f32 v12, v12, s45, -v246
    v_fma_f32 v13, v13, s45, -v246
    v_mfma_f32_16x16x32_bf16 v[120:123], v[208:211], v[184:187], v[120:123]
    ds_read_b128 v[196:199], v231 offset:10240
    v_exp_f32 v12, v12
    v_exp_f32 v13, v13
    v_cvt_pk_bf16_f32 v5, v10, v11
    v_fma_f32 v14, v14, s45, -v246
    v_fma_f32 v15, v15, s45, -v246
    s_waitcnt lgkmcnt(2)
    v_mfma_f32_16x16x32_bf16 v[116:119], v[212:215], v[176:179], v[116:119]
    v_max3_f32 v243, v243, v96, v97
    v_max3_f32 v244, v244, v104, v105
    v_max3_f32 v243, v243, v98, v99
    v_max3_f32 v244, v244, v106, v107
    v_exp_f32 v14, v14
    v_mfma_f32_16x16x32_bf16 v[124:127], v[212:215], v[184:187], v[124:127]
    ds_read_b128 v[200:203], v230 offset:12288
    v_exp_f32 v15, v15
    v_cvt_pk_bf16_f32 v6, v12, v13
    v_cvt_pk_bf16_f32 v7, v14, v15
    v_fma_f32 v16, v16, s45, -v245
    v_fma_f32 v17, v17, s45, -v245
    v_exp_f32 v16, v16
    s_waitcnt lgkmcnt(2)
    v_mfma_f32_16x16x32_bf16 v[112:115], v[192:195], v[180:183], v[112:115]
    v_max3_f32 v243, v243, v100, v101
    v_max3_f32 v244, v244, v108, v109
    v_max3_f32 v243, v243, v102, v103
    v_max3_f32 v244, v244, v110, v111
    v_exp_f32 v17, v17
    v_fma_f32 v18, v18, s45, -v245
    v_fma_f32 v19, v19, s45, -v245
    v_mfma_f32_16x16x32_bf16 v[120:123], v[192:195], v[188:191], v[120:123]
    ds_read_b128 v[204:207], v230 offset:14336
    v_exp_f32 v18, v18
    v_exp_f32 v19, v19
    v_cvt_pk_bf16_f32 v8, v16, v17
    v_fma_f32 v20, v20, s45, -v245
    v_fma_f32 v21, v21, s45, -v245
    s_waitcnt lgkmcnt(2)
    v_mfma_f32_16x16x32_bf16 v[116:119], v[196:199], v[180:183], v[116:119]
    v_exp_f32 v20, v20
    v_exp_f32 v21, v21
    v_cvt_pk_bf16_f32 v9, v18, v19
    v_fma_f32 v22, v22, s45, -v245
    v_fma_f32 v23, v23, s45, -v245
    v_mfma_f32_16x16x32_bf16 v[124:127], v[196:199], v[188:191], v[124:127]
    ds_read_b128 v[208:211], v231 offset:12288
    v_exp_f32 v22, v22
    v_exp_f32 v23, v23
    v_cvt_pk_bf16_f32 v10, v20, v21
    v_fma_f32 v24, v24, s45, -v246
    v_fma_f32 v25, v25, s45, -v246
    s_waitcnt lgkmcnt(2)
    v_mfma_f32_16x16x32_bf16 v[128:131], v[200:203], v[176:179], v[128:131]
    v_exp_f32 v24, v24
    v_exp_f32 v25, v25
    v_cvt_pk_bf16_f32 v11, v22, v23
    v_fma_f32 v26, v26, s45, -v246
    v_fma_f32 v27, v27, s45, -v246
    v_mfma_f32_16x16x32_bf16 v[136:139], v[200:203], v[184:187], v[136:139]
    ds_read_b128 v[212:215], v231 offset:14336
    v_exp_f32 v26, v26
    v_exp_f32 v27, v27
    v_cvt_pk_bf16_f32 v12, v24, v25
    v_fma_f32 v28, v28, s45, -v246
    v_fma_f32 v29, v29, s45, -v246
    s_waitcnt lgkmcnt(2)
    v_mfma_f32_16x16x32_bf16 v[132:135], v[204:207], v[176:179], v[132:135]
    v_max3_f32 v243, v243, v112, v113
    v_exp_f32 v28, v28
    v_exp_f32 v29, v29
    v_mfma_f32_16x16x32_bf16 v[140:143], v[204:207], v[184:187], v[140:143]
    s_waitcnt vmcnt(4)
    s_barrier
    s_add_u32 s47, s36, 32768
    v_add_u32 v230, s47, v226
    v_add_u32 v231, s47, v227
    v_add_u32 v232, s47, v228
    v_add_u32 v233, s47, v229
    ds_read_b64_tr_b16 v[192:193], v230 offset:4096
    ds_read_b64_tr_b16 v[194:195], v230 offset:6144
    s_add_u32 m0, s35, 98304
    s_add_u32 s46, s34, 49152
    buffer_load_dwordx4 v236, s[24:27], s46 offen offset:0 lds
    v_cvt_pk_bf16_f32 v13, v26, v27
    v_fma_f32 v30, v30, s45, -v246
    v_fma_f32 v31, v31, s45, -v246
    v_exp_f32 v30, v30
    s_waitcnt lgkmcnt(3)
    v_mfma_f32_16x16x32_bf16 v[128:131], v[208:211], v[180:183], v[128:131]
    v_max3_f32 v244, v244, v120, v121
    v_max3_f32 v243, v243, v114, v115
    v_max3_f32 v244, v244, v122, v123
    v_max3_f32 v243, v243, v116, v117
    v_max3_f32 v244, v244, v124, v125
    v_max3_f32 v243, v243, v118, v119
    v_max3_f32 v244, v244, v126, v127
    v_mfma_f32_16x16x32_bf16 v[136:139], v[208:211], v[188:191], v[136:139]
    ds_read_b64_tr_b16 v[196:197], v231 offset:4096
    ds_read_b64_tr_b16 v[198:199], v231 offset:6144
    v_exp_f32 v31, v31
    v_cvt_pk_bf16_f32 v14, v28, v29
    v_cvt_pk_bf16_f32 v15, v30, v31
    v_fma_f32 v32, v32, s45, -v245
    v_fma_f32 v33, v33, s45, -v245
    v_exp_f32 v32, v32
    s_waitcnt lgkmcnt(4)
    v_mfma_f32_16x16x32_bf16 v[132:135], v[212:215], v[180:183], v[132:135]
    v_exp_f32 v33, v33
    v_fma_f32 v34, v34, s45, -v245
    v_fma_f32 v35, v35, s45, -v245
    v_exp_f32 v34, v34
    v_exp_f32 v35, v35
    v_mfma_f32_16x16x32_bf16 v[140:143], v[212:215], v[188:191], v[140:143]
    ds_read_b64_tr_b16 v[200:201], v232 offset:4096
    ds_read_b64_tr_b16 v[202:203], v232 offset:6144
    v_cvt_pk_bf16_f32 v32, v32, v33
    v_fma_f32 v36, v36, s45, -v245
    v_fma_f32 v37, v37, s45, -v245
    v_exp_f32 v36, v36
    v_exp_f32 v37, v37
    s_waitcnt lgkmcnt(4)
    v_mfma_f32_16x16x32_bf16 v[144:147], v[192:195], v[0:3], 0
    v_cvt_pk_bf16_f32 v33, v34, v35
    v_fma_f32 v38, v38, s45, -v245
    v_fma_f32 v39, v39, s45, -v245
    v_exp_f32 v38, v38
    v_mfma_f32_16x16x32_bf16 v[160:163], v[192:195], v[4:7], 0
    ds_read_b64_tr_b16 v[204:205], v233 offset:4096
    ds_read_b64_tr_b16 v[206:207], v233 offset:6144
    s_add_u32 s46, s34, 51200
    buffer_load_dwordx4 v236, s[24:27], s46 offen offset:1024 lds
    v_exp_f32 v39, v39
    v_cvt_pk_bf16_f32 v34, v36, v37
    v_fma_f32 v40, v40, s45, -v246
    v_fma_f32 v41, v41, s45, -v246
    s_waitcnt lgkmcnt(4)
    v_mfma_f32_16x16x32_bf16 v[148:151], v[196:199], v[0:3], 0
    v_max3_f32 v243, v243, v128, v129
    v_max3_f32 v244, v244, v136, v137
    v_max3_f32 v243, v243, v130, v131
    v_max3_f32 v244, v244, v138, v139
    v_mfma_f32_16x16x32_bf16 v[164:167], v[196:199], v[4:7], 0
    ds_read_b64_tr_b16 v[208:209], v230 offset:8192
    ds_read_b64_tr_b16 v[210:211], v230 offset:10240
    v_exp_f32 v40, v40
    v_exp_f32 v41, v41
    v_cvt_pk_bf16_f32 v35, v38, v39
    v_fma_f32 v42, v42, s45, -v246
    s_waitcnt lgkmcnt(4)
    v_mfma_f32_16x16x32_bf16 v[152:155], v[200:203], v[0:3], 0
    v_max3_f32 v243, v243, v132, v133
    v_max3_f32 v244, v244, v140, v141
    v_max3_f32 v243, v243, v134, v135
    v_max3_f32 v244, v244, v142, v143
    v_fma_f32 v43, v43, s45, -v246
    v_mfma_f32_16x16x32_bf16 v[168:171], v[200:203], v[4:7], 0
    ds_read_b64_tr_b16 v[212:213], v231 offset:8192
    ds_read_b64_tr_b16 v[214:215], v231 offset:10240
    v_exp_f32 v42, v42
    v_exp_f32 v43, v43
    v_cvt_pk_bf16_f32 v36, v40, v41
    s_waitcnt lgkmcnt(4)
    v_mfma_f32_16x16x32_bf16 v[156:159], v[204:207], v[0:3], 0
    v_permlane32_swap_b32 v243, v244
    v_max_f32 v243, v243, v244
    v_mov_b32 v244, v243
    s_nop 1
    v_permlane16_swap_b32 v243, v244
    v_fma_f32 v44, v44, s45, -v246
    v_mfma_f32_16x16x32_bf16 v[172:175], v[204:207], v[4:7], 0
    ds_read_b64_tr_b16 v[192:193], v232 offset:8192
    ds_read_b64_tr_b16 v[194:195], v232 offset:10240
    s_add_u32 s46, s34, 53248
    buffer_load_dwordx4 v236, s[24:27], s46 offen offset:2048 lds
    v_fma_f32 v45, v45, s45, -v246
    v_exp_f32 v44, v44
    v_exp_f32 v45, v45
    s_waitcnt lgkmcnt(4)
    v_mfma_f32_16x16x32_bf16 v[144:147], v[208:211], v[8:11], v[144:147]
    v_max_f32 v243, v243, v244
    v_mov_b32 v244, v243
    s_nop 1
    v_permlane32_swap_b32 v243, v244
    v_mfma_f32_16x16x32_bf16 v[160:163], v[208:211], v[12:15], v[160:163]
    ds_read_b64_tr_b16 v[196:197], v233 offset:8192
    ds_read_b64_tr_b16 v[198:199], v233 offset:10240
    v_sub_f32 v251, v243, v241
    v_sub_f32 v254, v244, v242
    v_max_f32 v251, v251, v254
    v_cmp_lt_f32 vcc, 0x4319ac27, v251
    s_nop 1
    s_cmp_lg_u64 vcc, 0
    s_cbranch_scc1 L_rare_ml
L_back_ml:
    v_cvt_pk_bf16_f32 v37, v42, v43
    v_fma_f32 v46, v46, s45, -v246
    s_waitcnt lgkmcnt(4)
    v_mfma_f32_16x16x32_bf16 v[148:151], v[212:215], v[8:11], v[148:151]
    v_fma_f32 v47, v47, s45, -v246
    v_exp_f32 v46, v46
    v_exp_f32 v47, v47
    v_mfma_f32_16x16x32_bf16 v[164:167], v[212:215], v[12:15], v[164:167]
    ds_read_b64_tr_b16 v[200:201], v230 offset:12288
    ds_read_b64_tr_b16 v[202:203], v230 offset:14336
    v_cvt_pk_bf16_f32 v38, v44, v45
    v_cvt_pk_bf16_f32 v39, v46, v47
    v_fma_f32 v48, v48, s45, -v245
    v_fma_f32 v49, v49, s45, -v245
    s_waitcnt lgkmcnt(4)
    v_mfma_f32_16x16x32_bf16 v[152:155], v[192:195], v[8:11], v[152:155]
    v_exp_f32 v48, v48
    v_exp_f32 v49, v49
    v_fma_f32 v50, v50, s45, -v245
    v_mfma_f32_16x16x32_bf16 v[168:171], v[192:195], v[12:15], v[168:171]
    ds_read_b64_tr_b16 v[204:205], v231 offset:12288
    ds_read_b64_tr_b16 v[206:207], v231 offset:14336
    s_add_u32 s46, s34, 55296
    buffer_load_dwordx4 v236, s[24:27], s46 offen offset:3072 lds
    v_fma_f32 v51, v51, s45, -v245
    v_exp_f32 v50, v50
    v_exp_f32 v51, v51
    s_waitcnt lgkmcnt(4)
    v_mfma_f32_16x16x32_bf16 v[156:159], v[196:199], v[8:11], v[156:159]
    v_cvt_pk_bf16_f32 v40, v48, v49
    v_fma_f32 v52, v52, s45, -v245
    v_fma_f32 v53, v53, s45, -v245
    v_exp_f32 v52, v52
    v_mfma_f32_16x16x32_bf16 v[172:175], v[196:199], v[12:15], v[172:175]
    ds_read_b64_tr_b16 v[208:209], v232 offset:12288
    ds_read_b64_tr_b16 v[210:211], v232 offset:14336
    v_exp_f32 v53, v53
    v_cvt_pk_bf16_f32 v41, v50, v51
    v_fma_f32 v54, v54, s45, -v245
    v_fma_f32 v55, v55, s45, -v245
    s_waitcnt lgkmcnt(4)
    v_mfma_f32_16x16x32_bf16 v[144:147], v[200:203], v[32:35], v[144:147]
    v_exp_f32 v54, v54
    v_exp_f32 v55, v55
    v_cvt_pk_bf16_f32 v42, v52, v53
    v_mfma_f32_16x16x32_bf16 v[160:163], v[200:203], v[36:39], v[160:163]
    ds_read_b64_tr_b16 v[212:213], v233 offset:12288
    ds_read_b64_tr_b16 v[214:215], v233 offset:14336
    v_cvt_pk_bf16_f32 v43, v54, v55
    v_mov_b32 v44, 0
    v_fma_f32 v60, v60, s45, -v246
    v_fma_f32 v61, v61, s45, -v246
    s_waitcnt lgkmcnt(4)
    v_mfma_f32_16x16x32_bf16 v[148:151], v[204:207], v[32:35], v[148:151]
    v_exp_f32 v60, v60
    v_exp_f32 v61, v61
    v_mov_b32 v45, 0
    v_mfma_f32_16x16x32_bf16 v[164:167], v[204:207], v[36:39], v[164:167]
    ds_read_b64_tr_b16 v[192:193], v230 offset:0
    ds_read_b64_tr_b16 v[194:195], v230 offset:2048
    s_add_u32 m0, s35, 131072
    s_add_u32 s46, s34, 49280
    buffer_load_dwordx4 v236, s[24:27], s46 offen offset:0 lds
    v_fma_f32 v62, v62, s45, -v246
    v_fma_f32 v63, v63, s45, -v246
    v_exp_f32 v62, v62
    s_waitcnt lgkmcnt(4)
    v_mfma_f32_16x16x32_bf16 v[152:155], v[208:211], v[32:35], v[152:155]
    v_exp_f32 v63, v63
    v_cvt_pk_bf16_f32 v46, v60, v61
    v_cvt_pk_bf16_f32 v47, v62, v63
    v_fma_f32 v64, v64, s45, -v245
    v_mfma_f32_16x16x32_bf16 v[168:171], v[208:211], v[36:39], v[168:171]
    ds_read_b64_tr_b16 v[196:197], v231 offset:0
    ds_read_b64_tr_b16 v[198:199], v231 offset:2048
    v_fma_f32 v65, v65, s45, -v245
    v_exp_f32 v64, v64
    v_exp_f32 v65, v65
    s_waitcnt lgkmcnt(4)
    v_mfma_f32_16x16x32_bf16 v[156:159], v[212:215], v[32:35], v[156:159]
    v_fma_f32 v66, v66, s45, -v245
    v_fma_f32 v67, v67, s45, -v245
    v_exp_f32 v66, v66
    v_mfma_f32_16x16x32_bf16 v[172:175], v[212:215], v[36:39], v[172:175]
    ds_read_b64_tr_b16 v[200:201], v232 offset:0
    ds_read_b64_tr_b16 v[202:203], v232 offset:2048
    v_exp_f32 v67, v67
    v_cvt_pk_bf16_f32 v64, v64, v65
    v_cvt_pk_bf16_f32 v65, v66, v67
    v_mov_b32 v66, 0
    v_fma_f32 v72, v72, s45, -v246
    s_waitcnt lgkmcnt(4)
    v_mfma_f32_16x16x32_bf16 v[144:147], v[192:195], v[40:43], v[144:147]
    v_fma_f32 v73, v73, s45, -v246
    v_exp_f32 v72, v72
    v_exp_f32 v73, v73
    v_mfma_f32_16x16x32_bf16 v[160:163], v[192:195], v[44:47], v[160:163]
    ds_read_b64_tr_b16 v[204:205], v233 offset:0
    ds_read_b64_tr_b16 v[206:207], v233 offset:2048
    s_add_u32 s46, s34, 51328
    buffer_load_dwordx4 v236, s[24:27], s46 offen offset:1024 lds
    v_mov_b32 v67, 0
    v_fma_f32 v74, v74, s45, -v246
    v_fma_f32 v75, v75, s45, -v246
    v_exp_f32 v74, v74
    s_waitcnt lgkmcnt(4)
    v_mfma_f32_16x16x32_bf16 v[148:151], v[196:199], v[40:43], v[148:151]
    v_exp_f32 v75, v75
    v_cvt_pk_bf16_f32 v68, v72, v73
    v_fma_f32 v76, v76, s45, -v246
    v_fma_f32 v77, v77, s45, -v246
    v_mfma_f32_16x16x32_bf16 v[164:167], v[196:199], v[44:47], v[164:167]
    ds_read_b64_tr_b16 v[208:209], v230 offset:16384
    ds_read_b64_tr_b16 v[210:211], v230 offset:18432
    v_exp_f32 v76, v76
    v_exp_f32 v77, v77
    v_cvt_pk_bf16_f32 v69, v74, v75
    s_waitcnt lgkmcnt(4)
    v_mfma_f32_16x16x32_bf16 v[152:155], v[200:203], v[40:43], v[152:155]
    v_fma_f32 v78, v78, s45, -v246
    v_fma_f32 v79, v79, s45, -v246
    v_exp_f32 v78, v78
    v_mfma_f32_16x16x32_bf16 v[168:171], v[200:203], v[44:47], v[168:171]
    ds_read_b64_tr_b16 v[212:213], v231 offset:16384
    ds_read_b64_tr_b16 v[214:215], v231 offset:18432
    v_exp_f32 v79, v79
    v_cvt_pk_bf16_f32 v70, v76, v77
    v_cvt_pk_bf16_f32 v71, v78, v79
    s_waitcnt lgkmcnt(4)
    v_mfma_f32_16x16x32_bf16 v[156:159], v[204:207], v[40:43], v[156:159]
    v_fma_f32 v80, v80, s45, -v247
    v_fma_f32 v81, v81, s45, -v247
    v_mfma_f32_16x16x32_bf16 v[172:175], v[204:207], v[44:47], v[172:175]
    ds_read_b64_tr_b16 v[192:193], v232 offset:16384
    ds_read_b64_tr_b16 v[194:195], v232 offset:18432
    s_add_u32 s46, s34, 53376
    buffer_load_dwordx4 v236, s[24:27], s46 offen offset:2048 lds
    v_exp_f32 v80, v80
    s_waitcnt lgkmcnt(4)
    v_mfma_f32_16x16x32_bf16 v[144:147], v[208:211], v[64:67], v[144:147]
    v_exp_f32 v81, v81
    v_mfma_f32_16x16x32_bf16 v[160:163], v[208:211], v[68:71], v[160:163]
    ds_read_b64_tr_b16 v[196:197], v233 offset:16384
    ds_read_b64_tr_b16 v[198:199], v233 offset:18432
    v_fma_f32 v82, v82, s45, -v247
    v_fma_f32 v83, v83, s45, -v247
    s_waitcnt lgkmcnt(4)
    v_mfma_f32_16x16x32_bf16 v[148:151], v[212:215], v[64:67], v[148:151]
    v_mfma_f32_16x16x32_bf16 v[164:167], v[212:215], v[68:71], v[164:167]
    s_add_u32 s46, s34, 55424
    buffer_load_dwordx4 v236, s[24:27], s46 offen offset:3072 lds
    s_waitcnt vmcnt(8)
    s_barrier
    s_add_u32 s47, s36, 65536
    v_add_u32 v230, s47, v226
    v_add_u32 v231, s47, v227
    v_add_u32 v232, s47, v228
    v_add_u32 v233, s47, v229
    ds_read_b64_tr_b16 v[200:201], v230 offset:4096
    ds_read_b64_tr_b16 v[202:203], v230 offset:6144
    s_add_u32 m0, s35, 0
    s_add_u32 s46, s34, 256
    buffer_load_dwordx4 v236, s[24:27], s46 offen offset:0 lds
    s_waitcnt lgkmcnt(4)
    v_mfma_f32_16x16x32_bf16 v[152:155], v[192:195], v[64:67], v[152:155]
    v_exp_f32 v82, v82
    v_mfma_f32_16x16x32_bf16 v[168:171], v[192:195], v[68:71], v[168:171]
    ds_read_b64_tr_b16 v[204:205], v231 offset:4096
    ds_read_b64_tr_b16 v[206:207], v231 offset:6144
    v_exp_f32 v83, v83
    v_cvt_pk_bf16_f32 v72, v80, v81
    s_waitcnt lgkmcnt(4)
    v_mfma_f32_16x16x32_bf16 v[156:159], v[196:199], v[64:67], v[156:159]
    v_fma_f32 v84, v84, s45, -v247
    v_fma_f32 v85, v85, s45, -v247
    v_mfma_f32_16x16x32_bf16 v[172:175], v[196:199], v[68:71], v[172:175]
    ds_read_b64_tr_b16 v[208:209], v232 offset:4096
    ds_read_b64_tr_b16 v[210:211], v232 offset:6144
    v_exp_f32 v84, v84
    s_waitcnt lgkmcnt(4)
    v_mfma_f32_16x16x32_bf16 v[176:179], v[200:203], v[0:3], 0
    v_exp_f32 v85, v85
    v_cvt_pk_bf16_f32 v73, v82, v83
    v_mfma_f32_16x16x32_bf16 v[48:51], v[200:203], v[4:7], 0
    ds_read_b64_tr_b16 v[212:213], v233 offset:4096
    ds_read_b64_tr_b16 v[214:215], v233 offset:6144
    s_add_u32 s46, s34, 2304
    buffer_load_dwordx4 v236, s[24:27], s46 offen offset:1024 lds
    v_fma_f32 v86, v86, s45, -v247
    v_fma_f32 v87, v87, s45, -v247
    s_waitcnt lgkmcnt(4)
    v_mfma_f32_16x16x32_bf16 v[180:183], v[204:207], v[0:3], 0
    v_exp_f32 v86, v86
    v_mfma_f32_16x16x32_bf16 v[52:55], v[204:207], v[4:7], 0
    v_exp_f32 v87, v87
    v_cvt_pk_bf16_f32 v74, v84, v85
    s_waitcnt lgkmcnt(2)
    v_mfma_f32_16x16x32_bf16 v[184:187], v[208:211], v[0:3], 0
    v_fma_f32 v88, v88, s45, -v248
    v_fma_f32 v89, v89, s45, -v248
    v_mfma_f32_16x16x32_bf16 v[56:59], v[208:211], v[4:7], 0
    ds_read_b64_tr_b16 v[192:193], v230 offset:8192
    ds_read_b64_tr_b16 v[194:195], v230 offset:10240
    v_exp_f32 v88, v88
    s_waitcnt lgkmcnt(2)
    v_mfma_f32_16x16x32_bf16 v[188:191], v[212:215], v[0:3], 0
    v_exp_f32 v89, v89
    v_cvt_pk_bf16_f32 v75, v86, v87
    v_mfma_f32_16x16x32_bf16 v[60:63], v[212:215], v[4:7], 0
    ds_read_b64_tr_b16 v[196:197], v231 offset:8192
    ds_read_b64_tr_b16 v[198:199], v231 offset:10240
    s_add_u32 s46, s34, 4352
    buffer_load_dwordx4 v236, s[24:27], s46 offen offset:2048 lds
    v_fma_f32 v90, v90, s45, -v248
    v_fma_f32 v91, v91, s45, -v248
    v_mfma_f32_16x16x32_bf16 v[16:19], v[220:223], v[0:3], 0
    v_exp_f32 v90, v90
    v_exp_f32 v91, v91
    v_cvt_pk_bf16_f32 v76, v88, v89
    v_mfma_f32_16x16x32_bf16 v[20:23], v[220:223], v[4:7], 0
    ds_read_b64_tr_b16 v[200:201], v232 offset:8192
    ds_read_b64_tr_b16 v[202:203], v232 offset:10240
    v_fma_f32 v92, v92, s45, -v248
    v_fma_f32 v93, v93, s45, -v248
    v_exp_f32 v92, v92
    s_waitcnt lgkmcnt(4)
    v_mfma_f32_16x16x32_bf16 v[176:179], v[192:195], v[8:11], v[176:179]
    v_exp_f32 v93, v93
    v_cvt_pk_bf16_f32 v77, v90, v91
    v_mfma_f32_16x16x32_bf16 v[48:51], v[192:195], v[12:15], v[48:51]
    ds_read_b64_tr_b16 v[204:205], v233 offset:8192
    ds_read_b64_tr_b16 v[206:207], v233 offset:10240
    v_fma_f32 v94, v94, s45, -v248
    v_fma_f32 v95, v95, s45, -v248
    s_waitcnt lgkmcnt(4)
    v_mfma_f32_16x16x32_bf16 v[180:183], v[196:199], v[8:11], v[180:183]
    v_exp_f32 v94, v94
    v_mfma_f32_16x16x32_bf16 v[52:55], v[196:199], v[12:15], v[52:55]
    s_add_u32 s46, s34, 6400
    buffer_load_dwordx4 v236, s[24:27], s46 offen offset:3072 lds
    v_exp_f32 v95, v95
    v_cvt_pk_bf16_f32 v78, v92, v93
    s_waitcnt lgkmcnt(2)
    v_mfma_f32_16x16x32_bf16 v[184:187], v[200:203], v[8:11], v[184:187]
    v_cvt_pk_bf16_f32 v79, v94, v95
    v_fma_f32 v96, v96, s45, -v247
    v_fma_f32 v97, v97, s45, -v247
    v_mfma_f32_16x16x32_bf16 v[56:59], v[200:203], v[12:15], v[56:59]
    ds_read_b64_tr_b16 v[208:209], v230 offset:12288
    ds_read_b64_tr_b16 v[210:211], v230 offset:14336
    v_exp_f32 v96, v96
    s_waitcnt lgkmcnt(2)
    v_mfma_f32_16x16x32_bf16 v[188:191], v[204:207], v[8:11], v[188:191]
    v_exp_f32 v97, v97
    v_mfma_f32_16x16x32_bf16 v[60:63], v[204:207], v[12:15], v[60:63]
    ds_read_b64_tr_b16 v[212:213], v231 offset:12288
    ds_read_b64_tr_b16 v[214:215], v231 offset:14336
    v_fma_f32 v98, v98, s45, -v247
    v_fma_f32 v99, v99, s45, -v247
    v_mfma_f32_16x16x32_bf16 v[16:19], v[220:223], v[8:11], v[16:19]
    v_exp_f32 v98, v98
    v_exp_f32 v99, v99
    v_cvt_pk_bf16_f32 v96, v96, v97
    v_mfma_f32_16x16x32_bf16 v[20:23], v[220:223], v[12:15], v[20:23]
    ds_read_b64_tr_b16 v[192:193], v232 offset:12288
    ds_read_b64_tr_b16 v[194:195], v232 offset:14336
    v_fma_f32 v100, v100, s45, -v247
    v_fma_f32 v101, v101, s45, -v247
    v_exp_f32 v100, v100
    s_waitcnt lgkmcnt(4)
    v_mfma_f32_16x16x32_bf16 v[176:179], v[208:211], v[32:35], v[176:179]
    v_exp_f32 v101, v101
    v_cvt_pk_bf16_f32 v97, v98, v99
    v_mfma_f32_16x16x32_bf16 v[48:51], v[208:211], v[36:39], v[48:51]
    ds_read_b64_tr_b16 v[196:197], v233 offset:12288
    ds_read_b64_tr_b16 v[198:199], v233 offset:14336
    v_fma_f32 v102, v102, s45, -v247
    v_fma_f32 v103, v103, s45, -v247
    s_waitcnt lgkmcnt(4)
    v_mfma_f32_16x16x32_bf16 v[180:183], v[212:215], v[32:35], v[180:183]
    v_exp_f32 v102, v102
    v_mfma_f32_16x16x32_bf16 v[52:55], v[212:215], v[36:39], v[52:55]
    v_exp_f32 v103, v103
    v_cvt_pk_bf16_f32 v98, v100, v101
    s_waitcnt lgkmcnt(2)
    v_mfma_f32_16x16x32_bf16 v[184:187], v[192:195], v[32:35], v[184:187]
    v_fma_f32 v104, v104, s45, -v248
    v_fma_f32 v105, v105, s45, -v248
    v_mfma_f32_16x16x32_bf16 v[56:59], v[192:195], v[36:39], v[56:59]
    ds_read_b64_tr_b16 v[200:201], v230 offset:0
    ds_read_b64_tr_b16 v[202:203], v230 offset:2048
    v_exp_f32 v104, v104
    s_waitcnt lgkmcnt(2)
    v_mfma_f32_16x16x32_bf16 v[188:191], v[196:199], v[32:35], v[188:191]
    v_exp_f32 v105, v105
    v_cvt_pk_bf16_f32 v99, v102, v103
    v_mfma_f32_16x16x32_bf16 v[60:63], v[196:199], v[36:39], v[60:63]
    ds_read_b64_tr_b16 v[204:205], v231 offset:0
    ds_read_b64_tr_b16 v[206:207], v231 offset:2048
    v_fma_f32 v106, v106, s45, -v248
    v_fma_f32 v107, v107, s45, -v248
    v_mfma_f32_16x16x32_bf16 v[16:19], v[220:223], v[32:35], v[16:19]
    v_exp_f32 v106, v106
    v_exp_f32 v107, v107
    v_cvt_pk_bf16_f32 v100, v104, v105
    v_mfma_f32_16x16x32_bf16 v[20:23], v[220:223], v[36:39], v[20:23]
    ds_read_b64_tr_b16 v[208:209], v232 offset:0
    ds_read_b64_tr_b16 v[210:211], v232 offset:2048
    v_fma_f32 v108, v108, s45, -v248
    v_fma_f32 v109, v109, s45, -v248
    v_exp_f32 v108, v108
    s_waitcnt lgkmcnt(4)
    v_mfma_f32_16x16x32_bf16 v[176:179], v[200:203], v[40:43], v[176:179]
    v_exp_f32 v109, v109
    v_cvt_pk_bf16_f32 v101, v106, v107
    v_mfma_f32_16x16x32_bf16 v[48:51], v[200:203], v[44:47], v[48:51]
    ds_read_b64_tr_b16 v[212:213], v233 offset:0
    ds_read_b64_tr_b16 v[214:215], v233 offset:2048
    v_fma_f32 v110, v110, s45, -v248
    v_fma_f32 v111, v111, s45, -v248
    s_waitcnt lgkmcnt(4)
    v_mfma_f32_16x16x32_bf16 v[180:183], v[204:207], v[40:43], v[180:183]
    v_exp_f32 v110, v110
    v_mfma_f32_16x16x32_bf16 v[52:55], v[204:207], v[44:47], v[52:55]
    v_exp_f32 v111, v111
    v_cvt_pk_bf16_f32 v102, v108, v109
    s_waitcnt lgkmcnt(2)
    v_mfma_f32_16x16x32_bf16 v[184:187], v[208:211], v[40:43], v[184:187]
    v_cvt_pk_bf16_f32 v103, v110, v111
    v_fma_f32 v112, v112, s45, -v247
    v_fma_f32 v113, v113, s45, -v247
    v_mfma_f32_16x16x32_bf16 v[56:59], v[208:211], v[44:47], v[56:59]
    ds_read_b64_tr_b16 v[192:193], v230 offset:16384
    ds_read_b64_tr_b16 v[194:195], v230 offset:18432
    v_exp_f32 v112, v112
    s_waitcnt lgkmcnt(2)
    v_mfma_f32_16x16x32_bf16 v[188:191], v[212:215], v[40:43], v[188:191]
    v_exp_f32 v113, v113
    v_mfma_f32_16x16x32_bf16 v[60:63], v[212:215], v[44:47], v[60:63]
    ds_read_b64_tr_b16 v[196:197], v231 offset:16384
    ds_read_b64_tr_b16 v[198:199], v231 offset:18432
    v_fma_f32 v114, v114, s45, -v247
    v_fma_f32 v115, v115, s45, -v247
    v_mfma_f32_16x16x32_bf16 v[16:19], v[220:223], v[40:43], v[16:19]
    v_exp_f32 v114, v114
    v_exp_f32 v115, v115
    v_cvt_pk_bf16_f32 v104, v112, v113
    v_mfma_f32_16x16x32_bf16 v[20:23], v[220:223], v[44:47], v[20:23]
    ds_read_b64_tr_b16 v[200:201], v232 offset:16384
    ds_read_b64_tr_b16 v[202:203], v232 offset:18432
    v_fma_f32 v116, v116, s45, -v247
    v_fma_f32 v117, v117, s45, -v247
    v_exp_f32 v116, v116
    s_waitcnt lgkmcnt(4)
    v_mfma_f32_16x16x32_bf16 v[176:179], v[192:195], v[64:67], v[176:179]
    v_exp_f32 v117, v117
    v_cvt_pk_bf16_f32 v105, v114, v115
    v_mfma_f32_16x16x32_bf16 v[48:51], v[192:195], v[68:71], v[48:51]
    ds_read_b64_tr_b16 v[204:205], v233 offset:16384
    ds_read_b64_tr_b16 v[206:207], v233 offset:18432
    v_fma_f32 v118, v118, s45, -v247
    v_fma_f32 v119, v119, s45, -v247
    s_waitcnt lgkmcnt(4)
    v_mfma_f32_16x16x32_bf16 v[180:183], v[196:199], v[64:67], v[180:183]
    v_exp_f32 v118, v118
    v_mfma_f32_16x16x32_bf16 v[52:55], v[196:199], v[68:71], v[52:55]
    v_exp_f32 v119, v119
    v_cvt_pk_bf16_f32 v106, v116, v117
    s_waitcnt lgkmcnt(2)
    v_mfma_f32_16x16x32_bf16 v[184:187], v[200:203], v[64:67], v[184:187]
    v_fma_f32 v120, v120, s45, -v248
    v_mfma_f32_16x16x32_bf16 v[56:59], v[200:203], v[68:71], v[56:59]
    s_waitcnt vmcnt(8)
    s_barrier
    v_add_u32 v230, 98304, v226
    v_add_u32 v231, 98304, v227
    v_add_u32 v232, 98304, v228
    v_add_u32 v233, 98304, v229
    ds_read_b64_tr_b16 v[208:209], v230 offset:0
    ds_read_b64_tr_b16 v[210:211], v230 offset:2048
    s_add_u32 m0, s35, 32768
    s_add_u32 s46, s34, 49408
    buffer_load_dwordx4 v236, s[24:27], s46 offen offset:0 lds
    s_waitcnt lgkmcnt(2)
    v_mfma_f32_16x16x32_bf16 v[188:191], v[204:207], v[64:67], v[188:191]
    v_fma_f32 v121, v121, s45, -v248
    v_exp_f32 v120, v120
    v_mfma_f32_16x16x32_bf16 v[60:63], v[204:207], v[68:71], v[60:63]
    ds_read_b64_tr_b16 v[212:213], v231 offset:0
    ds_read_b64_tr_b16 v[214:215], v231 offset:2048
    v_exp_f32 v121, v121
    v_mfma_f32_16x16x32_bf16 v[16:19], v[220:223], v[64:67], v[16:19]
    v_cvt_pk_bf16_f32 v107, v118, v119
    v_fma_f32 v122, v122, s45, -v248
    v_fma_f32 v123, v123, s45, -v248
    v_exp_f32 v122, v122
    v_mfma_f32_16x16x32_bf16 v[20:23], v[220:223], v[68:71], v[20:23]
    ds_read_b64_tr_b16 v[192:193], v232 offset:0
    ds_read_b64_tr_b16 v[194:195], v232 offset:2048
    v_exp_f32 v123, v123
    v_cvt_pk_bf16_f32 v108, v120, v121
    v_fma_f32 v124, v124, s45, -v248
    s_cmp_lg_u32 s54, 0
    s_cbranch_scc1 L_rare_l0
L_back_l0:
    s_waitcnt lgkmcnt(4)
    v_mfma_f32_16x16x32_bf16 v[144:147], v[208:211], v[72:75], v[144:147]
    v_fma_f32 v125, v125, s45, -v248
    v_exp_f32 v124, v124
    v_mfma_f32_16x16x32_bf16 v[160:163], v[208:211], v[76:79], v[160:163]
    ds_read_b64_tr_b16 v[196:197], v233 offset:0
    ds_read_b64_tr_b16 v[198:199], v233 offset:2048
    s_add_u32 s46, s34, 51456
    buffer_load_dwordx4 v236, s[24:27], s46 offen offset:1024 lds
    v_exp_f32 v125, v125
    s_waitcnt lgkmcnt(4)
    v_mfma_f32_16x16x32_bf16 v[148:151], v[212:215], v[72:75], v[148:151]
    v_cvt_pk_bf16_f32 v109, v122, v123
    v_fma_f32 v126, v126, s45, -v248
    v_fma_f32 v127, v127, s45, -v248
    v_mfma_f32_16x16x32_bf16 v[164:167], v[212:215], v[76:79], v[164:167]
    v_exp_f32 v126, v126
    s_waitcnt lgkmcnt(2)
    v_mfma_f32_16x16x32_bf16 v[152:155], v[192:195], v[72:75], v[152:155]
    v_exp_f32 v127, v127
    v_cvt_pk_bf16_f32 v110, v124, v125
    v_mfma_f32_16x16x32_bf16 v[168:171], v[192:195], v[76:79], v[168:171]
    ds_read_b64_tr_b16 v[200:201], v230 offset:4096
    ds_read_b64_tr_b16 v[202:203], v230 offset:6144
    v_cvt_pk_bf16_f32 v111, v126, v127
    v_fma_f32 v128, v128, s45, -v247
    s_waitcnt lgkmcnt(2)
    v_mfma_f32_16x16x32_bf16 v[156:159], v[196:199], v[72:75], v[156:159]
    v_fma_f32 v129, v129, s45, -v247
    v_exp_f32 v128, v128
    v_mfma_f32_16x16x32_bf16 v[172:175], v[196:199], v[76:79], v[172:175]
    ds_read_b64_tr_b16 v[204:205], v231 offset:4096
    ds_read_b64_tr_b16 v[206:207], v231 offset:6144
    s_add_u32 s46, s34, 53504
    buffer_load_dwordx4 v236, s[24:27], s46 offen offset:2048 lds
    v_exp_f32 v129, v129
    v_mfma_f32_16x16x32_bf16 v[16:19], v[220:223], v[72:75], v[16:19]
    v_fma_f32 v130, v130, s45, -v247
    v_fma_f32 v131, v131, s45, -v247
    v_exp_f32 v130, v130
    v_mfma_f32_16x16x32_bf16 v[20:23], v[220:223], v[76:79], v[20:23]
    ds_read_b64_tr_b16 v[208:209], v232 offset:4096
    ds_read_b64_tr_b16 v[210:211], v232 offset:6144
    v_exp_f32 v131, v131
    v_cvt_pk_bf16_f32 v128, v128, v129
    v_fma_f32 v132, v132, s45, -v247
    v_fma_f32 v133, v133, s45, -v247
    s_waitcnt lgkmcnt(4)
    v_mfma_f32_16x16x32_bf16 v[144:147], v[200:203], v[96:99], v[144:147]
    v_exp_f32 v132, v132
    v_mfma_f32_16x16x32_bf16 v[160:163], v[200:203], v[100:103], v[160:163]
    ds_read_b64_tr_b16 v[212:213], v233 offset:4096
    ds_read_b64_tr_b16 v[214:215], v233 offset:6144
    v_exp_f32 v133, v133
    v_cvt_pk_bf16_f32 v129, v130, v131
    s_waitcnt lgkmcnt(4)
    v_mfma_f32_16x16x32_bf16 v[148:151], v[204:207], v[96:99], v[148:151]
    v_fma_f32 v134, v134, s45, -v247
    v_fma_f32 v135, v135, s45, -v247
    v_mfma_f32_16x16x32_bf16 v[164:167], v[204:207], v[100:103], v[164:167]
    s_add_u32 s46, s34, 55552
    buffer_load_dwordx4 v236, s[24:27], s46 offen offset:3072 lds
    v_exp_f32 v134, v134
    s_waitcnt lgkmcnt(2)
    v_mfma_f32_16x16x32_bf16 v[152:155], v[208:211], v[96:99], v[152:155]
    v_exp_f32 v135, v135
    v_cvt_pk_bf16_f32 v130, v132, v133
    v_mfma_f32_16x16x32_bf16 v[168:171], v[208:211], v[100:103], v[168:171]
    ds_read_b64_tr_b16 v[192:193], v230 offset:8192
    ds_read_b64_tr_b16 v[194:195], v230 offset:10240
    v_fma_f32 v136, v136, s45, -v248
    v_fma_f32 v137, v137, s45, -v248
    s_waitcnt lgkmcnt(2)
    v_mfma_f32_16x16x32_bf16 v[156:159], v[212:215], v[96:99], v[156:159]
    v_exp_f32 v136, v136
    v_mfma_f32_16x16x32_bf16 v[172:175], v[212:215], v[100:103], v[172:175]
    ds_read_b64_tr_b16 v[196:197], v231 offset:8192
    ds_read_b64_tr_b16 v[198:199], v231 offset:10240
    v_exp_f32 v137, v137
    v_cvt_pk_bf16_f32 v131, v134, v135
    v_mfma_f32_16x16x32_bf16 v[16:19], v[220:223], v[96:99], v[16:19]
    v_fma_f32 v138, v138, s45, -v248
    v_fma_f32 v139, v139, s45, -v248
    v_exp_f32 v138, v138
    v_mfma_f32_16x16x32_bf16 v[20:23], v[220:223], v[100:103], v[20:23]
    ds_read_b64_tr_b16 v[200:201], v232 offset:8192
    ds_read_b64_tr_b16 v[202:203], v232 offset:10240
    v_exp_f32 v139, v139
    v_cvt_pk_bf16_f32 v132, v136, v137
    v_fma_f32 v140, v140, s45, -v248
    v_fma_f32 v141, v141, s45, -v248
    s_waitcnt lgkmcnt(4)
    v_mfma_f32_16x16x32_bf16 v[144:147], v[192:195], v[104:107], v[144:147]
    v_exp_f32 v140, v140
    v_mfma_f32_16x16x32_bf16 v[160:163], v[192:195], v[108:111], v[160:163]
    ds_read_b64_tr_b16 v[204:205], v233 offset:8192
    ds_read_b64_tr_b16 v[206:207], v233 offset:10240
    v_exp_f32 v141, v141
    v_cvt_pk_bf16_f32 v133, v138, v139
    s_waitcnt lgkmcnt(4)
    v_mfma_f32_16x16x32_bf16 v[148:151], v[196:199], v[104:107], v[148:151]
    v_fma_f32 v142, v142, s45, -v248
    v_fma_f32 v143, v143, s45, -v248
    v_mfma_f32_16x16x32_bf16 v[164:167], v[196:199], v[108:111], v[164:167]
    v_exp_f32 v142, v142
    s_waitcnt lgkmcnt(2)
    v_mfma_f32_16x16x32_bf16 v[152:155], v[200:203], v[104:107], v[152:155]
    v_exp_f32 v143, v143
    v_mfma_f32_16x16x32_bf16 v[168:171], v[200:203], v[108:111], v[168:171]
    ds_read_b64_tr_b16 v[208:209], v230 offset:12288
    ds_read_b64_tr_b16 v[210:211], v230 offset:14336
    v_cvt_pk_bf16_f32 v134, v140, v141
    v_cvt_pk_bf16_f32 v135, v142, v143
    s_waitcnt lgkmcnt(2)
    v_mfma_f32_16x16x32_bf16 v[156:159], v[204:207], v[104:107], v[156:159]
    v_mfma_f32_16x16x32_bf16 v[172:175], v[204:207], v[108:111], v[172:175]
    ds_read_b64_tr_b16 v[212:213], v231 offset:12288
    ds_read_b64_tr_b16 v[214:215], v231 offset:14336
    v_mfma_f32_16x16x32_bf16 v[16:19], v[220:223], v[104:107], v[16:19]
    v_mfma_f32_16x16x32_bf16 v[20:23], v[220:223], v[108:111], v[20:23]
    ds_read_b64_tr_b16 v[192:193], v232 offset:12288
    ds_read_b64_tr_b16 v[194:195], v232 offset:14336
    s_waitcnt lgkmcnt(4)
    v_mfma_f32_16x16x32_bf16 v[144:147], v[208:211], v[128:131], v[144:147]
    v_mfma_f32_16x16x32_bf16 v[160:163], v[208:211], v[132:135], v[160:163]
    ds_read_b64_tr_b16 v[196:197], v233 offset:12288
    ds_read_b64_tr_b16 v[198:199], v233 offset:14336
    s_waitcnt lgkmcnt(4)
    v_mfma_f32_16x16x32_bf16 v[148:151], v[212:215], v[128:131], v[148:151]
    v_mfma_f32_16x16x32_bf16 v[164:167], v[212:215], v[132:135], v[164:167]
    s_waitcnt lgkmcnt(2)
    v_mfma_f32_16x16x32_bf16 v[152:155], v[192:195], v[128:131], v[152:155]
    v_mfma_f32_16x16x32_bf16 v[168:171], v[192:195], v[132:135], v[168:171]
    s_waitcnt vmcnt(8)
    s_barrier
    v_add_u32 v230, 131072, v226
    v_add_u32 v231, 131072, v227
    v_add_u32 v232, 131072, v228
    v_add_u32 v233, 131072, v229
    ds_read_b64_tr_b16 v[200:201], v230 offset:0
    ds_read_b64_tr_b16 v[202:203], v230 offset:2048
    s_waitcnt lgkmcnt(2)
    v_mfma_f32_16x16x32_bf16 v[156:159], v[196:199], v[128:131], v[156:159]
    v_mfma_f32_16x16x32_bf16 v[172:175], v[196:199], v[132:135], v[172:175]
    ds_read_b64_tr_b16 v[204:205], v231 offset:0
    ds_read_b64_tr_b16 v[206:207], v231 offset:2048
    v_mfma_f32_16x16x32_bf16 v[16:19], v[220:223], v[128:131], v[16:19]
    v_mfma_f32_16x16x32_bf16 v[20:23], v[220:223], v[132:135], v[20:23]
    ds_read_b64_tr_b16 v[208:209], v232 offset:0
    ds_read_b64_tr_b16 v[210:211], v232 offset:2048
    s_cmp_lg_u32 s54, 0
    s_cbranch_scc1 L_rare_l1
L_back_l1:
    s_waitcnt lgkmcnt(4)
    v_mfma_f32_16x16x32_bf16 v[176:179], v[200:203], v[72:75], v[176:179]
    v_mfma_f32_16x16x32_bf16 v[48:51], v[200:203], v[76:79], v[48:51]
    ds_read_b64_tr_b16 v[212:213], v233 offset:0
    ds_read_b64_tr_b16 v[214:215], v233 offset:2048
    s_waitcnt lgkmcnt(4)
    v_mfma_f32_16x16x32_bf16 v[180:183], v[204:207], v[72:75], v[180:183]
    v_rcp_f32 v243, v16
    v_mfma_f32_16x16x32_bf16 v[52:55], v[204:207], v[76:79], v[52:55]
    ds_read_b64_tr_b16 v[192:193], v230 offset:4096
    ds_read_b64_tr_b16 v[194:195], v230 offset:6144
    v_rcp_f32 v244, v20
    s_waitcnt lgkmcnt(4)
    v_mfma_f32_16x16x32_bf16 v[184:187], v[208:211], v[72:75], v[184:187]
    v_mul_f32 v144, v243, v144
    v_mul_f32 v145, v243, v145
    v_mul_f32 v146, v243, v146
    v_mfma_f32_16x16x32_bf16 v[56:59], v[208:211], v[76:79], v[56:59]
    ds_read_b64_tr_b16 v[196:197], v231 offset:4096
    ds_read_b64_tr_b16 v[198:199], v231 offset:6144
    v_mul_f32 v147, v243, v147
    v_cvt_pk_bf16_f32 v112, v144, v145
    s_waitcnt lgkmcnt(4)
    v_mfma_f32_16x16x32_bf16 v[188:191], v[212:215], v[72:75], v[188:191]
    v_cvt_pk_bf16_f32 v113, v146, v147
    ds_write_b64 v239, v[112:113] offset:32768
    v_mul_f32 v160, v244, v160
    v_mfma_f32_16x16x32_bf16 v[60:63], v[212:215], v[76:79], v[60:63]
    ds_read_b64_tr_b16 v[200:201], v232 offset:4096
    ds_read_b64_tr_b16 v[202:203], v232 offset:6144
    v_mul_f32 v161, v244, v161
    v_mul_f32 v162, v244, v162
    s_waitcnt lgkmcnt(5)
    v_mfma_f32_16x16x32_bf16 v[176:179], v[192:195], v[96:99], v[176:179]
    v_mul_f32 v163, v244, v163
    v_cvt_pk_bf16_f32 v114, v160, v161
    v_cvt_pk_bf16_f32 v115, v162, v163
    v_mfma_f32_16x16x32_bf16 v[48:51], v[192:195], v[100:103], v[48:51]
    ds_read_b64_tr_b16 v[204:205], v233 offset:4096
    ds_read_b64_tr_b16 v[206:207], v233 offset:6144
    ds_write_b64 v239, v[114:115] offset:34816
    v_xor_b32 v252, 32, v239
    s_waitcnt lgkmcnt(6)
    v_mfma_f32_16x16x32_bf16 v[180:183], v[196:199], v[96:99], v[180:183]
    v_mul_f32 v148, v243, v148
    v_mul_f32 v149, v243, v149
    v_mul_f32 v150, v243, v150
    v_mfma_f32_16x16x32_bf16 v[52:55], v[196:199], v[100:103], v[52:55]
    ds_read_b64_tr_b16 v[208:209], v230 offset:8192
    ds_read_b64_tr_b16 v[210:211], v230 offset:10240
    v_mul_f32 v151, v243, v151
    v_cvt_pk_bf16_f32 v116, v148, v149
    s_waitcnt lgkmcnt(5)
    v_mfma_f32_16x16x32_bf16 v[184:187], v[200:203], v[96:99], v[184:187]
    v_cvt_pk_bf16_f32 v117, v150, v151
    ds_write_b64 v252, v[116:117] offset:32768
    v_mul_f32 v164, v244, v164
    v_mfma_f32_16x16x32_bf16 v[56:59], v[200:203], v[100:103], v[56:59]
    ds_read_b64_tr_b16 v[212:213], v231 offset:8192
    ds_read_b64_tr_b16 v[214:215], v231 offset:10240
    v_mul_f32 v165, v244, v165
    v_mul_f32 v166, v244, v166
    s_waitcnt lgkmcnt(6)
    v_mfma_f32_16x16x32_bf16 v[188:191], v[204:207], v[96:99], v[188:191]
    v_mul_f32 v167, v244, v167
    v_cvt_pk_bf16_f32 v118, v164, v165
    v_cvt_pk_bf16_f32 v119, v166, v167
    v_mfma_f32_16x16x32_bf16 v[60:63], v[204:207], v[100:103], v[60:63]
    ds_read_b64_tr_b16 v[192:193], v232 offset:8192
    ds_read_b64_tr_b16 v[194:195], v232 offset:10240
    ds_write_b64 v252, v[118:119] offset:34816
    v_xor_b32 v253, 64, v239
    v_mul_f32 v152, v243, v152
    s_waitcnt lgkmcnt(6)
    v_mfma_f32_16x16x32_bf16 v[176:179], v[208:211], v[104:107], v[176:179]
    v_mul_f32 v153, v243, v153
    v_mul_f32 v154, v243, v154
    v_mul_f32 v155, v243, v155
    v_mfma_f32_16x16x32_bf16 v[48:51], v[208:211], v[108:111], v[48:51]
    ds_read_b64_tr_b16 v[196:197], v233 offset:8192
    ds_read_b64_tr_b16 v[198:199], v233 offset:10240
    v_cvt_pk_bf16_f32 v120, v152, v153
    v_cvt_pk_bf16_f32 v121, v154, v155
    s_waitcnt lgkmcnt(5)
    v_mfma_f32_16x16x32_bf16 v[180:183], v[212:215], v[104:107], v[180:183]
    ds_write_b64 v253, v[120:121] offset:32768
    v_mul_f32 v168, v244, v168
    v_mul_f32 v169, v244, v169
    v_mfma_f32_16x16x32_bf16 v[52:55], v[212:215], v[108:111], v[52:55]
    ds_read_b64_tr_b16 v[200:201], v230 offset:12288
    ds_read_b64_tr_b16 v[202:203], v230 offset:14336
    v_mul_f32 v170, v244, v170
    v_mul_f32 v171, v244, v171
    s_waitcnt lgkmcnt(6)
    v_mfma_f32_16x16x32_bf16 v[184:187], v[192:195], v[104:107], v[184:187]
    v_cvt_pk_bf16_f32 v122, v168, v169
    v_cvt_pk_bf16_f32 v123, v170, v171
    ds_write_b64 v253, v[122:123] offset:34816
    v_mfma_f32_16x16x32_bf16 v[56:59], v[192:195], v[108:111], v[56:59]
    ds_read_b64_tr_b16 v[204:205], v231 offset:12288
    ds_read_b64_tr_b16 v[206:207], v231 offset:14336
    v_xor_b32 v252, 96, v239
    v_mul_f32 v156, v243, v156
    s_waitcnt lgkmcnt(6)
    v_mfma_f32_16x16x32_bf16 v[188:191], v[196:199], v[104:107], v[188:191]
    v_mul_f32 v157, v243, v157
    v_mul_f32 v158, v243, v158
    v_mul_f32 v159, v243, v159
    v_mfma_f32_16x16x32_bf16 v[60:63], v[196:199], v[108:111], v[60:63]
    ds_read_b64_tr_b16 v[208:209], v232 offset:12288
    ds_read_b64_tr_b16 v[210:211], v232 offset:14336
    v_cvt_pk_bf16_f32 v124, v156, v157
    v_cvt_pk_bf16_f32 v125, v158, v159
    s_waitcnt lgkmcnt(5)
    v_mfma_f32_16x16x32_bf16 v[176:179], v[200:203], v[128:131], v[176:179]
    ds_write_b64 v252, v[124:125] offset:32768
    v_mul_f32 v172, v244, v172
    v_mul_f32 v173, v244, v173
    v_mfma_f32_16x16x32_bf16 v[48:51], v[200:203], v[132:135], v[48:51]
    ds_read_b64_tr_b16 v[212:213], v233 offset:12288
    ds_read_b64_tr_b16 v[214:215], v233 offset:14336
    v_mul_f32 v174, v244, v174
    v_mul_f32 v175, v244, v175
    s_waitcnt lgkmcnt(5)
    v_mfma_f32_16x16x32_bf16 v[180:183], v[204:207], v[128:131], v[180:183]
    v_cvt_pk_bf16_f32 v126, v172, v173
    v_mfma_f32_16x16x32_bf16 v[52:55], v[204:207], v[132:135], v[52:55]
    s_waitcnt vmcnt(4)
    s_barrier
    s_add_u32 s47, s36, 0
    v_add_u32 v230, s47, v226
    v_add_u32 v231, s47, v227
    v_add_u32 v232, s47, v228
    v_add_u32 v233, s47, v229
    ds_read_b64_tr_b16 v[192:193], v230 offset:4096
    ds_read_b64_tr_b16 v[194:195], v230 offset:6144
    s_waitcnt lgkmcnt(5)
    v_mfma_f32_16x16x32_bf16 v[184:187], v[208:211], v[128:131], v[184:187]
    v_cvt_pk_bf16_f32 v127, v174, v175
    ds_write_b64 v252, v[126:127] offset:34816
    ds_read_b128 v[112:115], v240 offset:32768
    v_mfma_f32_16x16x32_bf16 v[56:59], v[208:211], v[132:135], v[56:59]
    ds_read_b64_tr_b16 v[196:197], v231 offset:4096
    ds_read_b64_tr_b16 v[198:199], v231 offset:6144
    ds_read_b128 v[116:119], v240 offset:33792
    ds_read_b128 v[120:123], v240 offset:34816
    s_waitcnt lgkmcnt(8)
    v_mfma_f32_16x16x32_bf16 v[188:191], v[212:215], v[128:131], v[188:191]
    ds_read_b128 v[124:127], v240 offset:35840
    s_waitcnt lgkmcnt(5)
    buffer_store_dwordx4 v[112:115], v238, s[28:31], s32 offen offset:0 nt
    s_waitcnt lgkmcnt(2)
    buffer_store_dwordx4 v[116:119], v238, s[28:31], s32 offen offset:3072 nt
    v_mfma_f32_16x16x32_bf16 v[60:63], v[212:215], v[132:135], v[60:63]
    ds_read_b64_tr_b16 v[200:201], v232 offset:4096
    ds_read_b64_tr_b16 v[202:203], v232 offset:6144
    s_waitcnt lgkmcnt(3)
    buffer_store_dwordx4 v[120:123], v238, s[28:31], s33 offen offset:0 nt
    s_waitcnt lgkmcnt(2)
    buffer_store_dwordx4 v[124:127], v238, s[28:31], s33 offen offset:3072 nt
    v_mfma_f32_16x16x32_bf16 v[144:147], v[192:195], v[0:3], 0
    v_mfma_f32_16x16x32_bf16 v[160:163], v[192:195], v[4:7], 0
    ds_read_b64_tr_b16 v[204:205], v233 offset:4096
    ds_read_b64_tr_b16 v[206:207], v233 offset:6144
    v_mfma_f32_16x16x32_bf16 v[148:151], v[196:199], v[0:3], 0
    v_mfma_f32_16x16x32_bf16 v[164:167], v[196:199], v[4:7], 0
    ds_read_b64_tr_b16 v[208:209], v230 offset:8192
    ds_read_b64_tr_b16 v[210:211], v230 offset:10240
    s_waitcnt lgkmcnt(4)
    v_mfma_f32_16x16x32_bf16 v[152:155], v[200:203], v[0:3], 0
    v_mul_f32 v176, v243, v176
    v_mul_f32 v177, v243, v177
    v_mfma_f32_16x16x32_bf16 v[168:171], v[200:203], v[4:7], 0
    ds_read_b64_tr_b16 v[212:213], v231 offset:8192
    ds_read_b64_tr_b16 v[214:215], v231 offset:10240
    v_mul_f32 v178, v243, v178
    v_mul_f32 v179, v243, v179
    s_waitcnt lgkmcnt(4)
    v_mfma_f32_16x16x32_bf16 v[156:159], v[204:207], v[0:3], 0
    v_cvt_pk_bf16_f32 v112, v176, v177
    v_cvt_pk_bf16_f32 v113, v178, v179
    v_mfma_f32_16x16x32_bf16 v[172:175], v[204:207], v[4:7], 0
    ds_read_b64_tr_b16 v[192:193], v232 offset:8192
    ds_read_b64_tr_b16 v[194:195], v232 offset:10240
    ds_write_b64 v239, v[112:113] offset:32768
    v_mul_f32 v48, v244, v48
    s_waitcnt lgkmcnt(5)
    v_mfma_f32_16x16x32_bf16 v[144:147], v[208:211], v[8:11], v[144:147]
    v_mul_f32 v49, v244, v49
    v_mul_f32 v50, v244, v50
    v_mfma_f32_16x16x32_bf16 v[160:163], v[208:211], v[12:15], v[160:163]
    ds_read_b64_tr_b16 v[196:197], v233 offset:8192
    ds_read_b64_tr_b16 v[198:199], v233 offset:10240
    v_mul_f32 v51, v244, v51
    v_cvt_pk_bf16_f32 v114, v48, v49
    s_waitcnt lgkmcnt(5)
    v_mfma_f32_16x16x32_bf16 v[148:151], v[212:215], v[8:11], v[148:151]
    v_cvt_pk_bf16_f32 v115, v50, v51
    ds_write_b64 v239, v[114:115] offset:34816
    v_mfma_f32_16x16x32_bf16 v[164:167], v[212:215], v[12:15], v[164:167]
    ds_read_b64_tr_b16 v[200:201], v230 offset:12288
    ds_read_b64_tr_b16 v[202:203], v230 offset:14336
    v_xor_b32 v252, 32, v239
    v_mul_f32 v180, v243, v180
    s_waitcnt lgkmcnt(6)
    v_mfma_f32_16x16x32_bf16 v[152:155], v[192:195], v[8:11], v[152:155]
    v_mul_f32 v181, v243, v181
    v_mul_f32 v182, v243, v182
    v_mfma_f32_16x16x32_bf16 v[168:171], v[192:195], v[12:15], v[168:171]
    ds_read_b64_tr_b16 v[204:205], v231 offset:12288
    ds_read_b64_tr_b16 v[206:207], v231 offset:14336
    v_mul_f32 v183, v243, v183
    v_cvt_pk_bf16_f32 v116, v180, v181
    s_waitcnt lgkmcnt(5)
    v_mfma_f32_16x16x32_bf16 v[156:159], v[196:199], v[8:11], v[156:159]
    v_cvt_pk_bf16_f32 v117, v182, v183
    ds_write_b64 v252, v[116:117] offset:32768
    v_mfma_f32_16x16x32_bf16 v[172:175], v[196:199], v[12:15], v[172:175]
    ds_read_b64_tr_b16 v[208:209], v232 offset:12288
    ds_read_b64_tr_b16 v[210:211], v232 offset:14336
    v_mul_f32 v52, v244, v52
    s_waitcnt lgkmcnt(5)
    v_mfma_f32_16x16x32_bf16 v[144:147], v[200:203], v[32:35], v[144:147]
    v_mul_f32 v53, v244, v53
    v_mul_f32 v54, v244, v54
    v_mfma_f32_16x16x32_bf16 v[160:163], v[200:203], v[36:39], v[160:163]
    ds_read_b64_tr_b16 v[212:213], v233 offset:12288
    ds_read_b64_tr_b16 v[214:215], v233 offset:14336
    v_mul_f32 v55, v244, v55
    v_cvt_pk_bf16_f32 v118, v52, v53
    s_waitcnt lgkmcnt(5)
    v_mfma_f32_16x16x32_bf16 v[148:151], v[204:207], v[32:35], v[148:151]
    v_cvt_pk_bf16_f32 v119, v54, v55
    ds_write_b64 v252, v[118:119] offset:34816
    v_mfma_f32_16x16x32_bf16 v[164:167], v[204:207], v[36:39], v[164:167]
    ds_read_b64_tr_b16 v[192:193], v230 offset:0
    ds_read_b64_tr_b16 v[194:195], v230 offset:2048
    v_xor_b32 v253, 64, v239
    v_mul_f32 v184, v243, v184
    s_waitcnt lgkmcnt(5)
    v_mfma_f32_16x16x32_bf16 v[152:155], v[208:211], v[32:35], v[152:155]
    v_mul_f32 v185, v243, v185
    v_mul_f32 v186, v243, v186
    v_mfma_f32_16x16x32_bf16 v[168:171], v[208:211], v[36:39], v[168:171]
    ds_read_b64_tr_b16 v[196:197], v231 offset:0
    ds_read_b64_tr_b16 v[198:199], v231 offset:2048
    v_mul_f32 v187, v243, v187
    v_cvt_pk_bf16_f32 v120, v184, v185
    s_waitcnt lgkmcnt(5)
    v_mfma_f32_16x16x32_bf16 v[156:159], v[212:215], v[32:35], v[156:159]
    v_cvt_pk_bf16_f32 v121, v186, v187
    ds_write_b64 v253, v[120:121] offset:32768
    v_mfma_f32_16x16x32_bf16 v[172:175], v[212:215], v[36:39], v[172:175]
    ds_read_b64_tr_b16 v[200:201], v232 offset:0
    ds_read_b64_tr_b16 v[202:203], v232 offset:2048
    v_mul_f32 v56, v244, v56
    v_mul_f32 v57, v244, v57
    s_waitcnt lgkmcnt(5)
    v_mfma_f32_16x16x32_bf16 v[144:147], v[192:195], v[40:43], v[144:147]
    v_mul_f32 v58, v244, v58
    v_mul_f32 v59, v244, v59
    v_mfma_f32_16x16x32_bf16 v[160:163], v[192:195], v[44:47], v[160:163]
    ds_read_b64_tr_b16 v[204:205], v233 offset:0
    ds_read_b64_tr_b16 v[206:207], v233 offset:2048
    v_cvt_pk_bf16_f32 v122, v56, v57
    v_cvt_pk_bf16_f32 v123, v58, v59
    s_waitcnt lgkmcnt(5)
    v_mfma_f32_16x16x32_bf16 v[148:151], v[196:199], v[40:43], v[148:151]
    ds_write_b64 v253, v[122:123] offset:34816
    v_xor_b32 v252, 96, v239
    v_mfma_f32_16x16x32_bf16 v[164:167], v[196:199], v[44:47], v[164:167]
    ds_read_b64_tr_b16 v[208:209], v230 offset:16384
    ds_read_b64_tr_b16 v[210:211], v230 offset:18432
    v_mul_f32 v188, v243, v188
    v_mul_f32 v189, v243, v189
    s_waitcnt lgkmcnt(5)
    v_mfma_f32_16x16x32_bf16 v[152:155], v[200:203], v[40:43], v[152:155]
    v_mul_f32 v190, v243, v190
    v_mul_f32 v191, v243, v191
    v_mfma_f32_16x16x32_bf16 v[168:171], v[200:203], v[44:47], v[168:171]
    ds_read_b64_tr_b16 v[212:213], v231 offset:16384
    ds_read_b64_tr_b16 v[214:215], v231 offset:18432
    v_cvt_pk_bf16_f32 v124, v188, v189
    v_cvt_pk_bf16_f32 v125, v190, v191
    s_waitcnt lgkmcnt(5)
    v_mfma_f32_16x16x32_bf16 v[156:159], v[204:207], v[40:43], v[156:159]
    ds_write_b64 v252, v[124:125] offset:32768
    v_mul_f32 v60, v244, v60
    v_mfma_f32_16x16x32_bf16 v[172:175], v[204:207], v[44:47], v[172:175]
    ds_read_b64_tr_b16 v[192:193], v232 offset:16384
    ds_read_b64_tr_b16 v[194:195], v232 offset:18432
    v_mul_f32 v61, v244, v61
    v_mul_f32 v62, v244, v62
    s_waitcnt lgkmcnt(5)
    v_mfma_f32_16x16x32_bf16 v[144:147], v[208:211], v[64:67], v[144:147]
    v_mul_f32 v63, v244, v63
    v_cvt_pk_bf16_f32 v126, v60, v61
    v_mfma_f32_16x16x32_bf16 v[160:163], v[208:211], v[68:71], v[160:163]
    ds_read_b64_tr_b16 v[196:197], v233 offset:16384
    ds_read_b64_tr_b16 v[198:199], v233 offset:18432
    v_cvt_pk_bf16_f32 v127, v62, v63
    ds_write_b64 v252, v[126:127] offset:34816
    s_waitcnt lgkmcnt(6)
    v_mfma_f32_16x16x32_bf16 v[148:151], v[212:215], v[64:67], v[148:151]
    v_mfma_f32_16x16x32_bf16 v[164:167], v[212:215], v[68:71], v[164:167]
    s_waitcnt vmcnt(4)
    s_barrier
    v_add_u32 v230, 32768, v226
    v_add_u32 v231, 32768, v227
    v_add_u32 v232, 32768, v228
    v_add_u32 v233, 32768, v229
    ds_read_b64_tr_b16 v[200:201], v230 offset:0
    ds_read_b64_tr_b16 v[202:203], v230 offset:2048
    s_waitcnt lgkmcnt(5)
    v_mfma_f32_16x16x32_bf16 v[152:155], v[192:195], v[64:67], v[152:155]
    ds_read_b128 v[112:115], v240 offset:32768
    ds_read_b128 v[116:119], v240 offset:33792
    v_mfma_f32_16x16x32_bf16 v[168:171], v[192:195], v[68:71], v[168:171]
    ds_read_b64_tr_b16 v[204:205], v231 offset:0
    ds_read_b64_tr_b16 v[206:207], v231 offset:2048
    ds_read_b128 v[120:123], v240 offset:34816
    ds_read_b128 v[124:127], v240 offset:35840
    s_waitcnt lgkmcnt(9)
    v_mfma_f32_16x16x32_bf16 v[156:159], v[196:199], v[64:67], v[156:159]
    s_waitcnt lgkmcnt(5)
    buffer_store_dwordx4 v[112:115], v238, s[28:31], s32 offen offset:128 nt
    s_waitcnt lgkmcnt(4)
    buffer_store_dwordx4 v[116:119], v238, s[28:31], s32 offen offset:3200 nt
    v_mfma_f32_16x16x32_bf16 v[172:175], v[196:199], v[68:71], v[172:175]
    ds_read_b64_tr_b16 v[208:209], v232 offset:0
    ds_read_b64_tr_b16 v[210:211], v232 offset:2048
    s_waitcnt lgkmcnt(3)
    buffer_store_dwordx4 v[120:123], v238, s[28:31], s33 offen offset:128 nt
    s_waitcnt lgkmcnt(2)
    buffer_store_dwordx4 v[124:127], v238, s[28:31], s33 offen offset:3200 nt
    s_cmp_lg_u32 s54, 0
    s_cbranch_scc1 L_rare_l2
L_back_l2:
    v_mfma_f32_16x16x32_bf16 v[144:147], v[200:203], v[72:75], v[144:147]
    v_mfma_f32_16x16x32_bf16 v[160:163], v[200:203], v[76:79], v[160:163]
    ds_read_b64_tr_b16 v[212:213], v233 offset:0
    ds_read_b64_tr_b16 v[214:215], v233 offset:2048
    v_mfma_f32_16x16x32_bf16 v[148:151], v[204:207], v[72:75], v[148:151]
    v_mfma_f32_16x16x32_bf16 v[164:167], v[204:207], v[76:79], v[164:167]
    ds_read_b64_tr_b16 v[192:193], v230 offset:4096
    ds_read_b64_tr_b16 v[194:195], v230 offset:6144
    s_waitcnt lgkmcnt(4)
    v_mfma_f32_16x16x32_bf16 v[152:155], v[208:211], v[72:75], v[152:155]
    v_mfma_f32_16x16x32_bf16 v[168:171], v[208:211], v[76:79], v[168:171]
    ds_read_b64_tr_b16 v[196:197], v231 offset:4096
    ds_read_b64_tr_b16 v[198:199], v231 offset:6144
    s_waitcnt lgkmcnt(4)
    v_mfma_f32_16x16x32_bf16 v[156:159], v[212:215], v[72:75], v[156:159]
    v_mfma_f32_16x16x32_bf16 v[172:175], v[212:215], v[76:79], v[172:175]
    ds_read_b64_tr_b16 v[200:201], v232 offset:4096
    ds_read_b64_tr_b16 v[202:203], v232 offset:6144
    s_waitcnt lgkmcnt(4)
    v_mfma_f32_16x16x32_bf16 v[144:147], v[192:195], v[96:99], v[144:147]
    v_mfma_f32_16x16x32_bf16 v[160:163], v[192:195], v[100:103], v[160:163]
    ds_read_b64_tr_b16 v[204:205], v233 offset:4096
    ds_read_b64_tr_b16 v[206:207], v233 offset:6144
    s_waitcnt lgkmcnt(4)
    v_mfma_f32_16x16x32_bf16 v[148:151], v[196:199], v[96:99], v[148:151]
    v_mfma_f32_16x16x32_bf16 v[164:167], v[196:199], v[100:103], v[164:167]
    ds_read_b64_tr_b16 v[208:209], v230 offset:8192
    ds_read_b64_tr_b16 v[210:211], v230 offset:10240
    s_waitcnt lgkmcnt(4)
    v_mfma_f32_16x16x32_bf16 v[152:155], v[200:203], v[96:99], v[152:155]
    v_mfma_f32_16x16x32_bf16 v[168:171], v[200:203], v[100:103], v[168:171]
    ds_read_b64_tr_b16 v[212:213], v231 offset:8192
    ds_read_b64_tr_b16 v[214:215], v231 offset:10240
    s_waitcnt lgkmcnt(4)
    v_mfma_f32_16x16x32_bf16 v[156:159], v[204:207], v[96:99], v[156:159]
    v_mfma_f32_16x16x32_bf16 v[172:175], v[204:207], v[100:103], v[172:175]
    ds_read_b64_tr_b16 v[192:193], v232 offset:8192
    ds_read_b64_tr_b16 v[194:195], v232 offset:10240
    s_waitcnt lgkmcnt(4)
    v_mfma_f32_16x16x32_bf16 v[144:147], v[208:211], v[104:107], v[144:147]
    v_mfma_f32_16x16x32_bf16 v[160:163], v[208:211], v[108:111], v[160:163]
    ds_read_b64_tr_b16 v[196:197], v233 offset:8192
    ds_read_b64_tr_b16 v[198:199], v233 offset:10240
    s_waitcnt lgkmcnt(4)
    v_mfma_f32_16x16x32_bf16 v[148:151], v[212:215], v[104:107], v[148:151]
    v_mfma_f32_16x16x32_bf16 v[164:167], v[212:215], v[108:111], v[164:167]
    ds_read_b64_tr_b16 v[200:201], v230 offset:12288
    ds_read_b64_tr_b16 v[202:203], v230 offset:14336
    s_waitcnt lgkmcnt(4)
    v_mfma_f32_16x16x32_bf16 v[152:155], v[192:195], v[104:107], v[152:155]
    v_mfma_f32_16x16x32_bf16 v[168:171], v[192:195], v[108:111], v[168:171]
    ds_read_b64_tr_b16 v[204:205], v231 offset:12288
    ds_read_b64_tr_b16 v[206:207], v231 offset:14336
    s_waitcnt lgkmcnt(4)
    v_mfma_f32_16x16x32_bf16 v[156:159], v[196:199], v[104:107], v[156:159]
    v_mfma_f32_16x16x32_bf16 v[172:175], v[196:199], v[108:111], v[172:175]
    ds_read_b64_tr_b16 v[208:209], v232 offset:12288
    ds_read_b64_tr_b16 v[210:211], v232 offset:14336
    s_waitcnt lgkmcnt(4)
    v_mfma_f32_16x16x32_bf16 v[144:147], v[200:203], v[128:131], v[144:147]
    v_mfma_f32_16x16x32_bf16 v[160:163], v[200:203], v[132:135], v[160:163]
    ds_read_b64_tr_b16 v[212:213], v233 offset:12288
    ds_read_b64_tr_b16 v[214:215], v233 offset:14336
    s_waitcnt lgkmcnt(4)
    v_mfma_f32_16x16x32_bf16 v[148:151], v[204:207], v[128:131], v[148:151]
    v_mfma_f32_16x16x32_bf16 v[164:167], v[204:207], v[132:135], v[164:167]
    s_waitcnt lgkmcnt(2)
    v_mfma_f32_16x16x32_bf16 v[152:155], v[208:211], v[128:131], v[152:155]
    v_mfma_f32_16x16x32_bf16 v[168:171], v[208:211], v[132:135], v[168:171]
    s_waitcnt lgkmcnt(0)
    v_mfma_f32_16x16x32_bf16 v[156:159], v[212:215], v[128:131], v[156:159]
    v_mfma_f32_16x16x32_bf16 v[172:175], v[212:215], v[132:135], v[172:175]
    v_mul_f32 v144, v243, v144
    v_mul_f32 v145, v243, v145
    v_mul_f32 v146, v243, v146
    v_mul_f32 v147, v243, v147
    v_cvt_pk_bf16_f32 v112, v144, v145
    v_cvt_pk_bf16_f32 v113, v146, v147
    ds_write_b64 v239, v[112:113] offset:32768
    v_mul_f32 v160, v244, v160
    v_mul_f32 v161, v244, v161
    v_mul_f32 v162, v244, v162
    v_mul_f32 v163, v244, v163
    v_cvt_pk_bf16_f32 v114, v160, v161
    v_cvt_pk_bf16_f32 v115, v162, v163
    ds_write_b64 v239, v[114:115] offset:34816
    v_xor_b32 v252, 32, v239
    v_mul_f32 v148, v243, v148
    v_mul_f32 v149, v243, v149
    v_mul_f32 v150, v243, v150
    v_mul_f32 v151, v243, v151
    v_cvt_pk_bf16_f32 v116, v148, v149
    v_cvt_pk_bf16_f32 v117, v150, v151
    ds_write_b64 v252, v[116:117] offset:32768
    v_mul_f32 v164, v244, v164
    v_mul_f32 v165, v244, v165
    v_mul_f32 v166, v244, v166
    v_mul_f32 v167, v244, v167
    v_cvt_pk_bf16_f32 v118, v164, v165
    v_cvt_pk_bf16_f32 v119, v166, v167
    ds_write_b64 v252, v[118:119] offset:34816
    v_xor_b32 v253, 64, v239
    v_mul_f32 v152, v243, v152
    v_mul_f32 v153, v243, v153
    v_mul_f32 v154, v243, v154
    v_mul_f32 v155, v243, v155
    v_cvt_pk_bf16_f32 v120, v152, v153
    v_cvt_pk_bf16_f32 v121, v154, v155
    ds_write_b64 v253, v[120:121] offset:32768
    v_mul_f32 v168, v244, v168
    v_mul_f32 v169, v244, v169
    v_mul_f32 v170, v244, v170
    v_mul_f32 v171, v244, v171
    v_cvt_pk_bf16_f32 v122, v168, v169
    v_cvt_pk_bf16_f32 v123, v170, v171
    ds_write_b64 v253, v[122:123] offset:34816
    v_xor_b32 v252, 96, v239
    v_mul_f32 v156, v243, v156
    v_mul_f32 v157, v243, v157
    v_mul_f32 v158, v243, v158
    v_mul_f32 v159, v243, v159
    v_cvt_pk_bf16_f32 v124, v156, v157
    v_cvt_pk_bf16_f32 v125, v158, v159
    ds_write_b64 v252, v[124:125] offset:32768
    v_mul_f32 v172, v244, v172
    v_mul_f32 v173, v244, v173
    v_mul_f32 v174, v244, v174
    v_mul_f32 v175, v244, v175
    v_cvt_pk_bf16_f32 v126, v172, v173
    v_cvt_pk_bf16_f32 v127, v174, v175
    ds_write_b64 v252, v[126:127] offset:34816
    ds_read_b128 v[112:115], v240 offset:32768
    ds_read_b128 v[116:119], v240 offset:33792
    ds_read_b128 v[120:123], v240 offset:34816
    ds_read_b128 v[124:127], v240 offset:35840
    s_waitcnt lgkmcnt(3)
    buffer_store_dwordx4 v[112:115], v238, s[28:31], s32 offen offset:256 nt
    s_waitcnt lgkmcnt(2)
    buffer_store_dwordx4 v[116:119], v238, s[28:31], s32 offen offset:3328 nt
    s_waitcnt lgkmcnt(1)
    buffer_store_dwordx4 v[120:123], v238, s[28:31], s33 offen offset:256 nt
    s_waitcnt lgkmcnt(0)
    buffer_store_dwordx4 v[124:127], v238, s[28:31], s33 offen offset:3328 nt
    s_endpgm
L_hi:
    v_cmp_gt_i32 s[48:49], 0, v251
    v_cmp_gt_i32 s[50:51], 1, v251
    s_nop 0
    v_cndmask_b32 v128, 0, v249, s[48:49]
    v_cndmask_b32 v112, v249, v250, s[48:49]
    v_cmp_gt_i32 s[48:49], 2, v251
    v_cndmask_b32 v129, 0, v249, s[50:51]
    v_cndmask_b32 v113, v249, v250, s[50:51]
    v_cmp_gt_i32 s[50:51], 3, v251
    v_cndmask_b32 v130, 0, v249, s[48:49]
    v_cndmask_b32 v114, v249, v250, s[48:49]
    v_cmp_gt_i32 s[48:49], 16, v251
    v_cndmask_b32 v131, 0, v249, s[50:51]
    v_cndmask_b32 v115, v249, v250, s[50:51]
    v_cmp_gt_i32 s[50:51], 17, v251
    v_cndmask_b32 v116, v249, v250, s[48:49]
    v_cmp_gt_i32 s[48:49], 18, v251
    v_cndmask_b32 v117, v249, v250, s[50:51]
    v_cmp_gt_i32 s[50:51], 19, v251
    v_cndmask_b32 v118, v249, v250, s[48:49]
    v_cmp_gt_i32 s[48:49], -16, v251
    v_cndmask_b32 v119, v249, v250, s[50:51]
    v_cmp_gt_i32 s[50:51], -15, v251
    v_cndmask_b32 v136, 0, v249, s[48:49]
    v_cmp_gt_i32 s[48:49], -14, v251
    v_cndmask_b32 v137, 0, v249, s[50:51]
    v_cmp_gt_i32 s[50:51], -13, v251
    v_cndmask_b32 v138, 0, v249, s[48:49]
    v_cmp_gt_i32 s[48:49], 0, v251
    v_cndmask_b32 v139, 0, v249, s[50:51]
    v_cmp_gt_i32 s[50:51], 1, v251
    v_cndmask_b32 v140, 0, v249, s[48:49]
    v_cndmask_b32 v124, v249, v250, s[48:49]
    v_cmp_gt_i32 s[48:49], 2, v251
    v_cndmask_b32 v141, 0, v249, s[50:51]
    v_cndmask_b32 v125, v249, v250, s[50:51]
    v_cmp_gt_i32 s[50:51], 3, v251
    v_cndmask_b32 v142, 0, v249, s[48:49]
    v_cndmask_b32 v126, v249, v250, s[48:49]
    v_cndmask_b32 v143, 0, v249, s[50:51]
    v_cndmask_b32 v127, v249, v250, s[50:51]
    s_cmp_le_u32 s36, 8192
    s_cselect_b32 s37, s53, 0
    v_mov_b32 v64, s37
    v_mov_b32 v65, s37
    v_mov_b32 v66, s37
    v_mov_b32 v67, s37
    v_mov_b32 v68, s37
    v_mov_b32 v69, s37
    v_mov_b32 v70, s37
    v_mov_b32 v71, s37
    v_mov_b32 v72, s37
    v_mov_b32 v73, s37
    v_mov_b32 v74, s37
    v_mov_b32 v75, s37
    v_mov_b32 v76, s37
    v_mov_b32 v77, s37
    v_mov_b32 v78, s37
    v_mov_b32 v79, s37
    s_cmp_le_u32 s36, 4096
    s_cselect_b32 s38, s53, 0
    v_mov_b32 v80, s38
    v_mov_b32 v81, s38
    v_mov_b32 v82, s38
    v_mov_b32 v83, s38
    v_mov_b32 v84, s38
    v_mov_b32 v85, s38
    v_mov_b32 v86, s38
    v_mov_b32 v87, s38
    v_mov_b32 v88, s38
    v_mov_b32 v89, s38
    v_mov_b32 v90, s38
    v_mov_b32 v91, s38
    v_mov_b32 v92, s38
    v_mov_b32 v93, s38
    v_mov_b32 v94, s38
    v_mov_b32 v95, s38
    s_cmp_le_u32 s36, 0
    s_cselect_b32 s39, s53, 0
    v_mov_b32 v96, s39
    v_mov_b32 v97, s39
    v_mov_b32 v98, s39
    v_mov_b32 v99, s39
    v_mov_b32 v100, s39
    v_mov_b32 v101, s39
    v_mov_b32 v102, s39
    v_mov_b32 v103, s39
    v_mov_b32 v104, s39
    v_mov_b32 v105, s39
    v_mov_b32 v106, s39
    v_mov_b32 v107, s39
    v_mov_b32 v108, s39
    v_mov_b32 v109, s39
    v_mov_b32 v110, s39
    v_mov_b32 v111, s39
    s_waitcnt vmcnt(12)
    s_barrier
    v_add_u32 v230, 16384, v224
    v_add_u32 v231, 16384, v225
    ds_read_b128 v[192:195], v230 offset:0
    ds_read_b128 v[196:199], v230 offset:2048
    ds_read_b128 v[200:203], v231 offset:0
    s_waitcnt vmcnt(11) lgkmcnt(2)
    v_mfma_f32_16x16x32_bf16 v[0:3], v[192:195], v[144:147], 0
    s_waitcnt vmcnt(10)
    v_mfma_f32_16x16x32_bf16 v[8:11], v[192:195], v[152:155], 0
    ds_read_b128 v[204:207], v231 offset:2048
    s_add_u32 m0, s35, 65536
    s_add_u32 s46, s34, 128
    buffer_load_dwordx4 v234, s[20:23], s46 offen offset:0 lds
    s_waitcnt lgkmcnt(2)
    v_mfma_f32_16x16x32_bf16 v[4:7], v[196:199], v[144:147], 0
    v_mfma_f32_16x16x32_bf16 v[12:15], v[196:199], v[152:155], 0
    ds_read_b128 v[208:211], v230 offset:4096
    s_waitcnt vmcnt(10) lgkmcnt(2)
    v_mfma_f32_16x16x32_bf16 v[0:3], v[200:203], v[148:151], v[0:3]
    s_waitcnt vmcnt(9)
    v_mfma_f32_16x16x32_bf16 v[8:11], v[200:203], v[156:159], v[8:11]
    ds_read_b128 v[212:215], v230 offset:6144
    s_waitcnt lgkmcnt(2)
    v_mfma_f32_16x16x32_bf16 v[4:7], v[204:207], v[148:151], v[4:7]
    v_mfma_f32_16x16x32_bf16 v[12:15], v[204:207], v[156:159], v[12:15]
    ds_read_b128 v[192:195], v231 offset:4096
    buffer_load_dwordx4 v235, s[20:23], s46 offen offset:1024 lds
    s_waitcnt lgkmcnt(2)
    v_mfma_f32_16x16x32_bf16 v[16:19], v[208:211], v[144:147], 0
    v_mfma_f32_16x16x32_bf16 v[24:27], v[208:211], v[152:155], 0
    ds_read_b128 v[196:199], v231 offset:6144
    s_waitcnt lgkmcnt(2)
    v_mfma_f32_16x16x32_bf16 v[20:23], v[212:215], v[144:147], 0
    v_mfma_f32_16x16x32_bf16 v[28:31], v[212:215], v[152:155], 0
    ds_read_b128 v[200:203], v230 offset:8192
    s_waitcnt lgkmcnt(2)
    v_mfma_f32_16x16x32_bf16 v[16:19], v[192:195], v[148:151], v[16:19]
    v_mfma_f32_16x16x32_bf16 v[24:27], v[192:195], v[156:159], v[24:27]
    ds_read_b128 v[204:207], v230 offset:10240
    s_add_u32 s46, s34, 4224
    buffer_load_dwordx4 v234, s[20:23], s46 offen offset:2048 lds
    s_waitcnt lgkmcnt(2)
    v_mfma_f32_16x16x32_bf16 v[20:23], v[196:199], v[148:151], v[20:23]
    v_mfma_f32_16x16x32_bf16 v[28:31], v[196:199], v[156:159], v[28:31]
    ds_read_b128 v[208:211], v231 offset:8192
    s_waitcnt lgkmcnt(2)
    v_mfma_f32_16x16x32_bf16 v[32:35], v[200:203], v[144:147], 0
    v_mfma_f32_16x16x32_bf16 v[40:43], v[200:203], v[152:155], 0
    ds_read_b128 v[212:215], v231 offset:10240
    s_waitcnt lgkmcnt(2)
    v_mfma_f32_16x16x32_bf16 v[36:39], v[204:207], v[144:147], 0
    v_mfma_f32_16x16x32_bf16 v[44:47], v[204:207], v[152:155], 0
    ds_read_b128 v[192:195], v230 offset:12288
    buffer_load_dwordx4 v235, s[20:23], s46 offen offset:3072 lds
    s_waitcnt lgkmcnt(2)
    v_mfma_f32_16x16x32_bf16 v[32:35], v[208:211], v[148:151], v[32:35]
    v_mfma_f32_16x16x32_bf16 v[40:43], v[208:211], v[156:159], v[40:43]
    ds_read_b128 v[196:199], v230 offset:14336
    s_waitcnt lgkmcnt(2)
    v_mfma_f32_16x16x32_bf16 v[36:39], v[212:215], v[148:151], v[36:39]
    v_mfma_f32_16x16x32_bf16 v[44:47], v[212:215], v[156:159], v[44:47]
    ds_read_b128 v[200:203], v231 offset:12288
    s_waitcnt lgkmcnt(2)
    v_mfma_f32_16x16x32_bf16 v[48:51], v[192:195], v[144:147], 0
    v_mfma_f32_16x16x32_bf16 v[56:59], v[192:195], v[152:155], 0
    ds_read_b128 v[204:207], v231 offset:14336
    s_waitcnt lgkmcnt(2)
    v_mfma_f32_16x16x32_bf16 v[52:55], v[196:199], v[144:147], 0
    v_mfma_f32_16x16x32_bf16 v[60:63], v[196:199], v[152:155], 0
    s_waitcnt vmcnt(8)
    s_barrier
    s_add_u32 s47, s36, 32768
    v_add_u32 v230, s47, v224
    v_add_u32 v231, s47, v225
    ds_read_b128 v[208:211], v230 offset:4096
    buffer_load_dwordx4 v[176:179], v237, s[16:19], s32 offen offset:256
    s_waitcnt lgkmcnt(2)
    v_mfma_f32_16x16x32_bf16 v[48:51], v[200:203], v[148:151], v[48:51]
    v_mfma_f32_16x16x32_bf16 v[56:59], v[200:203], v[156:159], v[56:59]
    ds_read_b128 v[212:215], v230 offset:6144
    s_waitcnt lgkmcnt(2)
    v_mfma_f32_16x16x32_bf16 v[52:55], v[204:207], v[148:151], v[52:55]
    v_mfma_f32_16x16x32_bf16 v[60:63], v[204:207], v[156:159], v[60:63]
    ds_read_b128 v[192:195], v231 offset:4096
    s_waitcnt lgkmcnt(2)
    v_mfma_f32_16x16x32_bf16 v[64:67], v[208:211], v[144:147], v[64:67]
    v_mfma_f32_16x16x32_bf16 v[72:75], v[208:211], v[152:155], v[72:75]
    ds_read_b128 v[196:199], v231 offset:6144
    buffer_load_dwordx4 v[180:183], v237, s[16:19], s32 offen offset:320
    s_waitcnt lgkmcnt(2)
    v_mfma_f32_16x16x32_bf16 v[68:71], v[212:215], v[144:147], v[68:71]
    v_mfma_f32_16x16x32_bf16 v[76:79], v[212:215], v[152:155], v[76:79]
    ds_read_b128 v[200:203], v230 offset:8192
    s_waitcnt lgkmcnt(2)
    v_mfma_f32_16x16x32_bf16 v[64:67], v[192:195], v[148:151], v[64:67]
    v_mfma_f32_16x16x32_bf16 v[72:75], v[192:195], v[156:159], v[72:75]
    ds_read_b128 v[204:207], v230 offset:10240
    s_waitcnt lgkmcnt(2)
    v_mfma_f32_16x16x32_bf16 v[68:71], v[196:199], v[148:151], v[68:71]
    v_mfma_f32_16x16x32_bf16 v[76:79], v[196:199], v[156:159], v[76:79]
    ds_read_b128 v[208:211], v231 offset:8192
    s_add_u32 m0, s35, 98304
    s_add_u32 s46, s34, 49280
    buffer_load_dwordx4 v234, s[20:23], s46 offen offset:0 lds
    s_waitcnt lgkmcnt(2)
    v_mfma_f32_16x16x32_bf16 v[80:83], v[200:203], v[144:147], v[80:83]
    v_mfma_f32_16x16x32_bf16 v[88:91], v[200:203], v[152:155], v[88:91]
    ds_read_b128 v[212:215], v231 offset:10240
    s_waitcnt lgkmcnt(2)
    v_mfma_f32_16x16x32_bf16 v[84:87], v[204:207], v[144:147], v[84:87]
    v_mfma_f32_16x16x32_bf16 v[92:95], v[204:207], v[152:155], v[92:95]
    ds_read_b128 v[192:195], v230 offset:12288
    s_waitcnt lgkmcnt(2)
    v_mfma_f32_16x16x32_bf16 v[80:83], v[208:211], v[148:151], v[80:83]
    v_mfma_f32_16x16x32_bf16 v[88:91], v[208:211], v[156:159], v[88:91]
    ds_read_b128 v[196:199], v230 offset:14336
    buffer_load_dwordx4 v235, s[20:23], s46 offen offset:1024 lds
    s_waitcnt lgkmcnt(2)
    v_mfma_f32_16x16x32_bf16 v[84:87], v[212:215], v[148:151], v[84:87]
    v_mfma_f32_16x16x32_bf16 v[92:95], v[212:215], v[156:159], v[92:95]
    ds_read_b128 v[200:203], v231 offset:12288
    s_waitcnt lgkmcnt(2)
    v_mfma_f32_16x16x32_bf16 v[96:99], v[192:195], v[144:147], v[96:99]
    v_mfma_f32_16x16x32_bf16 v[104:107], v[192:195], v[152:155], v[104:107]
    ds_read_b128 v[204:207], v231 offset:14336
    s_waitcnt lgkmcnt(2)
    v_mfma_f32_16x16x32_bf16 v[100:103], v[196:199], v[144:147], v[100:103]
    v_mfma_f32_16x16x32_bf16 v[108:111], v[196:199], v[152:155], v[108:111]
    ds_read_b128 v[208:211], v230 offset:0
    s_add_u32 s46, s34, 53376
    buffer_load_dwordx4 v234, s[20:23], s46 offen offset:2048 lds
    s_waitcnt lgkmcnt(2)
    v_mfma_f32_16x16x32_bf16 v[96:99], v[200:203], v[148:151], v[96:99]
    v_mfma_f32_16x16x32_bf16 v[104:107], v[200:203], v[156:159], v[104:107]
    ds_read_b128 v[212:215], v230 offset:2048
    s_waitcnt lgkmcnt(2)
    v_mfma_f32_16x16x32_bf16 v[100:103], v[204:207], v[148:151], v[100:103]
    v_mfma_f32_16x16x32_bf16 v[108:111], v[204:207], v[156:159], v[108:111]
    ds_read_b128 v[192:195], v231 offset:0
    s_waitcnt lgkmcnt(2)
    v_mfma_f32_16x16x32_bf16 v[112:115], v[208:211], v[144:147], v[112:115]
    ds_read_b128 v[196:199], v231 offset:2048
    buffer_load_dwordx4 v235, s[20:23], s46 offen offset:3072 lds
    s_waitcnt lgkmcnt(2)
    v_mfma_f32_16x16x32_bf16 v[116:119], v[212:215], v[144:147], v[116:119]
    v_mfma_f32_16x16x32_bf16 v[124:127], v[212:215], v[152:155], v[124:127]
    ds_read_b128 v[200:203], v230 offset:16384
    s_waitcnt lgkmcnt(2)
    v_mfma_f32_16x16x32_bf16 v[112:115], v[192:195], v[148:151], v[112:115]
    ds_read_b128 v[204:207], v230 offset:18432
    s_waitcnt lgkmcnt(2)
    v_mfma_f32_16x16x32_bf16 v[116:119], v[196:199], v[148:151], v[116:119]
    v_mfma_f32_16x16x32_bf16 v[124:127], v[196:199], v[156:159], v[124:127]
    ds_read_b128 v[208:211], v231 offset:16384
    s_waitcnt lgkmcnt(2)
    v_mfma_f32_16x16x32_bf16 v[128:131], v[200:203], v[144:147], v[128:131]
    v_mfma_f32_16x16x32_bf16 v[136:139], v[200:203], v[152:155], v[136:139]
    ds_read_b128 v[212:215], v231 offset:18432
    s_waitcnt lgkmcnt(2)
    v_mfma_f32_16x16x32_bf16 v[140:143], v[204:207], v[152:155], v[140:143]
    s_waitcnt vmcnt(6)
    s_barrier
    v_add_u32 v230, 81920, v224
    v_add_u32 v231, 81920, v225
    ds_read_b128 v[192:195], v230 offset:0
    buffer_load_dwordx4 v[184:187], v237, s[16:19], s33 offen offset:256
    s_waitcnt lgkmcnt(2)
    v_mfma_f32_16x16x32_bf16 v[128:131], v[208:211], v[148:151], v[128:131]
    v_mfma_f32_16x16x32_bf16 v[136:139], v[208:211], v[156:159], v[136:139]
    ds_read_b128 v[196:199], v230 offset:2048
    s_waitcnt lgkmcnt(2)
    v_mfma_f32_16x16x32_bf16 v[140:143], v[212:215], v[156:159], v[140:143]
    ds_read_b128 v[200:203], v231 offset:0
    s_waitcnt lgkmcnt(2)
    v_mfma_f32_16x16x32_bf16 v[0:3], v[192:195], v[160:163], v[0:3]
    v_mfma_f32_16x16x32_bf16 v[8:11], v[192:195], v[168:171], v[8:11]
    ds_read_b128 v[204:207], v231 offset:2048
    buffer_load_dwordx4 v[188:191], v237, s[16:19], s33 offen offset:320
    s_waitcnt lgkmcnt(2)
    v_mfma_f32_16x16x32_bf16 v[4:7], v[196:199], v[160:163], v[4:7]
    v_mfma_f32_16x16x32_bf16 v[12:15], v[196:199], v[168:171], v[12:15]
    ds_read_b128 v[208:211], v230 offset:4096
    s_waitcnt lgkmcnt(2)
    v_mfma_f32_16x16x32_bf16 v[0:3], v[200:203], v[164:167], v[0:3]
    v_mfma_f32_16x16x32_bf16 v[8:11], v[200:203], v[172:175], v[8:11]
    ds_read_b128 v[212:215], v230 offset:6144
    s_waitcnt lgkmcnt(2)
    v_mfma_f32_16x16x32_bf16 v[4:7], v[204:207], v[164:167], v[4:7]
    v_mfma_f32_16x16x32_bf16 v[12:15], v[204:207], v[172:175], v[12:15]
    ds_read_b128 v[192:195], v231 offset:4096
    s_add_u32 m0, s35, 131072
    s_add_u32 s46, s34, 256
    buffer_load_dwordx4 v234, s[20:23], s46 offen offset:0 lds
    s_waitcnt lgkmcnt(2)
    v_mfma_f32_16x16x32_bf16 v[16:19], v[208:211], v[160:163], v[16:19]
    v_mfma_f32_16x16x32_bf16 v[24:27], v[208:211], v[168:171], v[24:27]
    ds_read_b128 v[196:199], v231 offset:6144
    s_waitcnt lgkmcnt(2)
    v_mfma_f32_16x16x32_bf16 v[20:23], v[212:215], v[160:163], v[20:23]
    v_mfma_f32_16x16x32_bf16 v[28:31], v[212:215], v[168:171], v[28:31]
    ds_read_b128 v[200:203], v230 offset:8192
    s_waitcnt lgkmcnt(2)
    v_mfma_f32_16x16x32_bf16 v[16:19], v[192:195], v[164:167], v[16:19]
    v_mfma_f32_16x16x32_bf16 v[24:27], v[192:195], v[172:175], v[24:27]
    ds_read_b128 v[204:207], v230 offset:10240
    buffer_load_dwordx4 v235, s[20:23], s46 offen offset:1024 lds
    s_waitcnt lgkmcnt(2)
    v_mfma_f32_16x16x32_bf16 v[20:23], v[196:199], v[164:167], v[20:23]
    v_mfma_f32_16x16x32_bf16 v[28:31], v[196:199], v[172:175], v[28:31]
    ds_read_b128 v[208:211], v231 offset:8192
    s_waitcnt lgkmcnt(2)
    v_mfma_f32_16x16x32_bf16 v[32:35], v[200:203], v[160:163], v[32:35]
    v_mfma_f32_16x16x32_bf16 v[40:43], v[200:203], v[168:171], v[40:43]
    ds_read_b128 v[212:215], v231 offset:10240
    s_waitcnt lgkmcnt(2)
    v_mfma_f32_16x16x32_bf16 v[36:39], v[204:207], v[160:163], v[36:39]
    v_mfma_f32_16x16x32_bf16 v[44:47], v[204:207], v[168:171], v[44:47]
    ds_read_b128 v[192:195], v230 offset:12288
    s_add_u32 s46, s34, 4352
    buffer_load_dwordx4 v234, s[20:23], s46 offen offset:2048 lds
    s_waitcnt lgkmcnt(2)
    v_mfma_f32_16x16x32_bf16 v[32:35], v[208:211], v[164:167], v[32:35]
    v_mfma_f32_16x16x32_bf16 v[40:43], v[208:211], v[172:175], v[40:43]
    ds_read_b128 v[196:199], v230 offset:14336
    s_waitcnt lgkmcnt(2)
    v_mfma_f32_16x16x32_bf16 v[36:39], v[212:215], v[164:167], v[36:39]
    v_mfma_f32_16x16x32_bf16 v[44:47], v[212:215], v[172:175], v[44:47]
    ds_read_b128 v[200:203], v231 offset:12288
    s_waitcnt lgkmcnt(2)
    v_mfma_f32_16x16x32_bf16 v[48:51], v[192:195], v[160:163], v[48:51]
    v_mfma_f32_16x16x32_bf16 v[56:59], v[192:195], v[168:171], v[56:59]
    ds_read_b128 v[204:207], v231 offset:14336
    buffer_load_dwordx4 v235, s[20:23], s46 offen offset:3072 lds
    s_waitcnt lgkmcnt(2)
    v_mfma_f32_16x16x32_bf16 v[52:55], v[196:199], v[160:163], v[52:55]
    v_mfma_f32_16x16x32_bf16 v[60:63], v[196:199], v[168:171], v[60:63]
    s_waitcnt vmcnt(6)
    s_barrier
    s_add_u32 s47, s36, 98304
    v_add_u32 v230, s47, v224
    v_add_u32 v231, s47, v225
    ds_read_b128 v[208:211], v230 offset:4096
    s_add_u32 m0, s35, 0
    s_add_u32 s46, s34, 49408
    buffer_load_dwordx4 v234, s[20:23], s46 offen offset:0 lds
    s_waitcnt lgkmcnt(2)
    v_mfma_f32_16x16x32_bf16 v[48:51], v[200:203], v[164:167], v[48:51]
    v_mfma_f32_16x16x32_bf16 v[56:59], v[200:203], v[172:175], v[56:59]
    ds_read_b128 v[212:215], v230 offset:6144
    s_waitcnt lgkmcnt(2)
    v_mfma_f32_16x16x32_bf16 v[52:55], v[204:207], v[164:167], v[52:55]
    v_mfma_f32_16x16x32_bf16 v[60:63], v[204:207], v[172:175], v[60:63]
    ds_read_b128 v[192:195], v231 offset:4096
    s_waitcnt lgkmcnt(2)
    v_mfma_f32_16x16x32_bf16 v[64:67], v[208:211], v[160:163], v[64:67]
    v_mfma_f32_16x16x32_bf16 v[72:75], v[208:211], v[168:171], v[72:75]
    ds_read_b128 v[196:199], v231 offset:6144
    buffer_load_dwordx4 v235, s[20:23], s46 offen offset:1024 lds
    s_waitcnt lgkmcnt(2)
    v_mfma_f32_16x16x32_bf16 v[68:71], v[212:215], v[160:163], v[68:71]
    v_mfma_f32_16x16x32_bf16 v[76:79], v[212:215], v[168:171], v[76:79]
    ds_read_b128 v[200:203], v230 offset:8192
    s_waitcnt lgkmcnt(2)
    v_mfma_f32_16x16x32_bf16 v[64:67], v[192:195], v[164:167], v[64:67]
    v_mfma_f32_16x16x32_bf16 v[72:75], v[192:195], v[172:175], v[72:75]
    ds_read_b128 v[204:207], v230 offset:10240
    s_waitcnt lgkmcnt(2)
    v_mfma_f32_16x16x32_bf16 v[68:71], v[196:199], v[164:167], v[68:71]
    v_mfma_f32_16x16x32_bf16 v[76:79], v[196:199], v[172:175], v[76:79]
    ds_read_b128 v[208:211], v231 offset:8192
    s_add_u32 s46, s34, 53504
    buffer_load_dwordx4 v234, s[20:23], s46 offen offset:2048 lds
    s_waitcnt lgkmcnt(2)
    v_mfma_f32_16x16x32_bf16 v[80:83], v[200:203], v[160:163], v[80:83]
    v_mfma_f32_16x16x32_bf16 v[88:91], v[200:203], v[168:171], v[88:91]
    ds_read_b128 v[212:215], v231 offset:10240
    s_waitcnt lgkmcnt(2)
    v_mfma_f32_16x16x32_bf16 v[84:87], v[204:207], v[160:163], v[84:87]
    v_mfma_f32_16x16x32_bf16 v[92:95], v[204:207], v[168:171], v[92:95]
    ds_read_b128 v[192:195], v230 offset:12288
    s_waitcnt lgkmcnt(2)
    v_mfma_f32_16x16x32_bf16 v[80:83], v[208:211], v[164:167], v[80:83]
    v_mfma_f32_16x16x32_bf16 v[88:91], v[208:211], v[172:175], v[88:91]
    ds_read_b128 v[196:199], v230 offset:14336
    buffer_load_dwordx4 v235, s[20:23], s46 offen offset:3072 lds
    s_waitcnt lgkmcnt(2)
    v_mfma_f32_16x16x32_bf16 v[84:87], v[212:215], v[164:167], v[84:87]
    v_mfma_f32_16x16x32_bf16 v[92:95], v[212:215], v[172:175], v[92:95]
    ds_read_b128 v[200:203], v231 offset:12288
    s_waitcnt lgkmcnt(2)
    v_mfma_f32_16x16x32_bf16 v[96:99], v[192:195], v[160:163], v[96:99]
    v_mfma_f32_16x16x32_bf16 v[104:107], v[192:195], v[168:171], v[104:107]
    ds_read_b128 v[204:207], v231 offset:14336
    s_waitcnt lgkmcnt(2)
    v_mfma_f32_16x16x32_bf16 v[100:103], v[196:199], v[160:163], v[100:103]
    v_mfma_f32_16x16x32_bf16 v[108:111], v[196:199], v[168:171], v[108:111]
    ds_read_b128 v[208:211], v230 offset:0
    s_waitcnt lgkmcnt(2)
    v_mfma_f32_16x16x32_bf16 v[96:99], v[200:203], v[164:167], v[96:99]
    v_mfma_f32_16x16x32_bf16 v[104:107], v[200:203], v[172:175], v[104:107]
    ds_read_b128 v[212:215], v230 offset:2048
    s_waitcnt lgkmcnt(2)
    v_mfma_f32_16x16x32_bf16 v[100:103], v[204:207], v[164:167], v[100:103]
    v_mfma_f32_16x16x32_bf16 v[108:111], v[204:207], v[172:175], v[108:111]
    ds_read_b128 v[192:195], v231 offset:0
    s_waitcnt lgkmcnt(2)
    v_mfma_f32_16x16x32_bf16 v[112:115], v[208:211], v[160:163], v[112:115]
    ds_read_b128 v[196:199], v231 offset:2048
    s_waitcnt lgkmcnt(2)
    v_mfma_f32_16x16x32_bf16 v[116:119], v[212:215], v[160:163], v[116:119]
    v_mfma_f32_16x16x32_bf16 v[124:127], v[212:215], v[168:171], v[124:127]
    ds_read_b128 v[200:203], v230 offset:16384
    s_waitcnt lgkmcnt(2)
    v_mfma_f32_16x16x32_bf16 v[112:115], v[192:195], v[164:167], v[112:115]
    ds_read_b128 v[204:207], v230 offset:18432
    s_waitcnt lgkmcnt(2)
    v_mfma_f32_16x16x32_bf16 v[116:119], v[196:199], v[164:167], v[116:119]
    v_mfma_f32_16x16x32_bf16 v[124:127], v[196:199], v[172:175], v[124:127]
    ds_read_b128 v[208:211], v231 offset:16384
    s_waitcnt lgkmcnt(2)
    v_mfma_f32_16x16x32_bf16 v[128:131], v[200:203], v[160:163], v[128:131]
    v_mfma_f32_16x16x32_bf16 v[136:139], v[200:203], v[168:171], v[136:139]
    ds_read_b128 v[212:215], v231 offset:18432
    s_waitcnt lgkmcnt(2)
    v_mfma_f32_16x16x32_bf16 v[140:143], v[204:207], v[168:171], v[140:143]
    s_waitcnt vmcnt(4)
    s_barrier
    v_add_u32 v230, 147456, v224
    v_add_u32 v231, 147456, v225
    ds_read_b128 v[192:195], v230 offset:0
    s_add_u32 m0, s35, 32768
    s_add_u32 s46, s34, 0
    buffer_load_dwordx4 v236, s[24:27], s46 offen offset:0 lds
    s_waitcnt lgkmcnt(2)
    v_mfma_f32_16x16x32_bf16 v[128:131], v[208:211], v[164:167], v[128:131]
    v_mfma_f32_16x16x32_bf16 v[136:139], v[208:211], v[172:175], v[136:139]
    ds_read_b128 v[196:199], v230 offset:2048
    s_waitcnt lgkmcnt(2)
    v_mfma_f32_16x16x32_bf16 v[140:143], v[212:215], v[172:175], v[140:143]
    ds_read_b128 v[200:203], v231 offset:0
    s_waitcnt lgkmcnt(2)
    v_mfma_f32_16x16x32_bf16 v[0:3], v[192:195], v[176:179], v[0:3]
    v_mfma_f32_16x16x32_bf16 v[8:11], v[192:195], v[184:187], v[8:11]
    ds_read_b128 v[204:207], v231 offset:2048
    s_add_u32 s46, s34, 2048
    buffer_load_dwordx4 v236, s[24:27], s46 offen offset:1024 lds
    s_waitcnt lgkmcnt(2)
    v_mfma_f32_16x16x32_bf16 v[4:7], v[196:199], v[176:179], v[4:7]
    v_mfma_f32_16x16x32_bf16 v[12:15], v[196:199], v[184:187], v[12:15]
    ds_read_b128 v[208:211], v230 offset:4096
    s_waitcnt lgkmcnt(2)
    v_mfma_f32_16x16x32_bf16 v[0:3], v[200:203], v[180:183], v[0:3]
    v_mfma_f32_16x16x32_bf16 v[8:11], v[200:203], v[188:191], v[8:11]
    ds_read_b128 v[212:215], v230 offset:6144
    s_waitcnt lgkmcnt(2)
    v_mfma_f32_16x16x32_bf16 v[4:7], v[204:207], v[180:183], v[4:7]
    v_mfma_f32_16x16x32_bf16 v[12:15], v[204:207], v[188:191], v[12:15]
    ds_read_b128 v[192:195], v231 offset:4096
    s_add_u32 s46, s34, 4096
    buffer_load_dwordx4 v236, s[24:27], s46 offen offset:2048 lds
    s_waitcnt lgkmcnt(2)
    v_mfma_f32_16x16x32_bf16 v[16:19], v[208:211], v[176:179], v[16:19]
    v_mfma_f32_16x16x32_bf16 v[24:27], v[208:211], v[184:187], v[24:27]
    ds_read_b128 v[196:199], v231 offset:6144
    s_waitcnt lgkmcnt(2)
    v_mfma_f32_16x16x32_bf16 v[20:23], v[212:215], v[176:179], v[20:23]
    v_max3_f32 v241, v0, v1, v2
    v_max3_f32 v242, v8, v9, v10
    v_mfma_f32_16x16x32_bf16 v[28:31], v[212:215], v[184:187], v[28:31]
    ds_read_b128 v[200:203], v230 offset:8192
    v_max3_f32 v241, v241, v3, v4
    v_max3_f32 v242, v242, v11, v12
    s_waitcnt lgkmcnt(2)
    v_mfma_f32_16x16x32_bf16 v[16:19], v[192:195], v[180:183], v[16:19]
    v_max3_f32 v241, v241, v5, v6
    v_max3_f32 v242, v242, v13, v14
    v_mfma_f32_16x16x32_bf16 v[24:27], v[192:195], v[188:191], v[24:27]
    ds_read_b128 v[204:207], v230 offset:10240
    s_add_u32 s46, s34, 6144
    buffer_load_dwordx4 v236, s[24:27], s46 offen offset:3072 lds
    v_max_f32 v241, v241, v7
    v_max_f32 v242, v242, v15
    s_waitcnt lgkmcnt(2)
    v_mfma_f32_16x16x32_bf16 v[20:23], v[196:199], v[180:183], v[20:23]
    v_mfma_f32_16x16x32_bf16 v[28:31], v[196:199], v[188:191], v[28:31]
    ds_read_b128 v[208:211], v231 offset:8192
    s_waitcnt lgkmcnt(2)
    v_mfma_f32_16x16x32_bf16 v[32:35], v[200:203], v[176:179], v[32:35]
    v_mfma_f32_16x16x32_bf16 v[40:43], v[200:203], v[184:187], v[40:43]
    ds_read_b128 v[212:215], v231 offset:10240
    s_waitcnt lgkmcnt(2)
    v_mfma_f32_16x16x32_bf16 v[36:39], v[204:207], v[176:179], v[36:39]
    v_max3_f32 v241, v241, v16, v17
    v_max3_f32 v242, v242, v24, v25
    v_mfma_f32_16x16x32_bf16 v[44:47], v[204:207], v[184:187], v[44:47]
    ds_read_b128 v[192:195], v230 offset:12288
    v_max3_f32 v241, v241, v18, v19
    v_max3_f32 v242, v242, v26, v27
    s_waitcnt lgkmcnt(2)
    v_mfma_f32_16x16x32_bf16 v[32:35], v[208:211], v[180:183], v[32:35]
    v_max3_f32 v241, v241, v20, v21
    v_max3_f32 v242, v242, v28, v29
    v_mfma_f32_16x16x32_bf16 v[40:43], v[208:211], v[188:191], v[40:43]
    ds_read_b128 v[196:199], v230 offset:14336
    v_max3_f32 v241, v241, v22, v23
    v_max3_f32 v242, v242, v30, v31
    s_waitcnt lgkmcnt(2)
    v_mfma_f32_16x16x32_bf16 v[36:39], v[212:215], v[180:183], v[36:39]
    v_mfma_f32_16x16x32_bf16 v[44:47], v[212:215], v[188:191], v[44:47]
    ds_read_b128 v[200:203], v231 offset:12288
    s_waitcnt lgkmcnt(2)
    v_mfma_f32_16x16x32_bf16 v[48:51], v[192:195], v[176:179], v[48:51]
    v_mfma_f32_16x16x32_bf16 v[56:59], v[192:195], v[184:187], v[56:59]
    ds_read_b128 v[204:207], v231 offset:14336
    s_waitcnt lgkmcnt(2)
    v_mfma_f32_16x16x32_bf16 v[52:55], v[196:199], v[176:179], v[52:55]
    v_max3_f32 v241, v241, v32, v33
    v_mfma_f32_16x16x32_bf16 v[60:63], v[196:199], v[184:187], v[60:63]
    s_waitcnt vmcnt(4)
    s_barrier
    s_add_u32 s47, s36, 0
    v_add_u32 v230, s47, v224
    v_add_u32 v231, s47, v225
    ds_read_b128 v[208:211], v230 offset:4096
    s_add_u32 m0, s35, 65536
    s_add_u32 s46, s34, 128
    buffer_load_dwordx4 v236, s[24:27], s46 offen offset:0 lds
    v_max3_f32 v242, v242, v40, v41
    s_waitcnt lgkmcnt(2)
    v_mfma_f32_16x16x32_bf16 v[48:51], v[200:203], v[180:183], v[48:51]
    v_max3_f32 v241, v241, v34, v35
    v_max3_f32 v242, v242, v42, v43
    v_max3_f32 v241, v241, v36, v37
    v_mfma_f32_16x16x32_bf16 v[56:59], v[200:203], v[188:191], v[56:59]
    ds_read_b128 v[212:215], v230 offset:6144
    v_max3_f32 v242, v242, v44, v45
    v_max3_f32 v241, v241, v38, v39
    v_max3_f32 v242, v242, v46, v47
    s_waitcnt lgkmcnt(2)
    v_mfma_f32_16x16x32_bf16 v[52:55], v[204:207], v[180:183], v[52:55]
    v_mfma_f32_16x16x32_bf16 v[60:63], v[204:207], v[188:191], v[60:63]
    ds_read_b128 v[192:195], v231 offset:4096
    s_waitcnt lgkmcnt(2)
    v_mfma_f32_16x16x32_bf16 v[64:67], v[208:211], v[176:179], v[64:67]
    v_mfma_f32_16x16x32_bf16 v[72:75], v[208:211], v[184:187], v[72:75]
    ds_read_b128 v[196:199], v231 offset:6144
    s_add_u32 s46, s34, 2176
    buffer_load_dwordx4 v236, s[24:27], s46 offen offset:1024 lds
    s_waitcnt lgkmcnt(2)
    v_mfma_f32_16x16x32_bf16 v[68:71], v[212:215], v[176:179], v[68:71]
    v_max3_f32 v241, v241, v48, v49
    v_max3_f32 v242, v242, v56, v57
    v_mfma_f32_16x16x32_bf16 v[76:79], v[212:215], v[184:187], v[76:79]
    ds_read_b128 v[200:203], v230 offset:8192
    v_max3_f32 v241, v241, v50, v51
    v_max3_f32 v242, v242, v58, v59
    s_waitcnt lgkmcnt(2)
    v_mfma_f32_16x16x32_bf16 v[64:67], v[192:195], v[180:183], v[64:67]
    v_max3_f32 v241, v241, v52, v53
    v_max3_f32 v242, v242, v60, v61
    v_mfma_f32_16x16x32_bf16 v[72:75], v[192:195], v[188:191], v[72:75]
    ds_read_b128 v[204:207], v230 offset:10240
    v_max3_f32 v241, v241, v54, v55
    v_max3_f32 v242, v242, v62, v63
    s_waitcnt lgkmcnt(2)
    v_mfma_f32_16x16x32_bf16 v[68:71], v[196:199], v[180:183], v[68:71]
    v_permlane32_swap_b32 v241, v242
    v_max_f32 v241, v241, v242
    v_mov_b32 v242, v241
    v_mfma_f32_16x16x32_bf16 v[76:79], v[196:199], v[188:191], v[76:79]
    ds_read_b128 v[208:211], v231 offset:8192
    s_add_u32 s46, s34, 4224
    buffer_load_dwordx4 v236, s[24:27], s46 offen offset:2048 lds
    v_permlane16_swap_b32 v241, v242
    v_max_f32 v241, v241, v242
    v_mov_b32 v242, v241
    s_waitcnt lgkmcnt(2)
    v_mfma_f32_16x16x32_bf16 v[80:83], v[200:203], v[176:179], v[80:83]
    v_permlane32_swap_b32 v241, v242
    v_mul_f32 v245, s45, v241
    v_mul_f32 v247, s45, v241
    v_mfma_f32_16x16x32_bf16 v[88:91], v[200:203], v[184:187], v[88:91]
    ds_read_b128 v[212:215], v231 offset:10240
    v_mul_f32 v246, s45, v242
    v_mul_f32 v248, s45, v242
    s_waitcnt lgkmcnt(2)
    v_mfma_f32_16x16x32_bf16 v[84:87], v[204:207], v[176:179], v[84:87]
    v_max3_f32 v243, v64, v65, v66
    v_max3_f32 v244, v72, v73, v74
    v_max3_f32 v243, v243, v67, v68
    v_max3_f32 v244, v244, v75, v76
    v_fma_f32 v0, v0, s45, -v245
    v_fma_f32 v1, v1, s45, -v245
    v_mfma_f32_16x16x32_bf16 v[92:95], v[204:207], v[184:187], v[92:95]
    ds_read_b128 v[192:195], v230 offset:12288
    v_exp_f32 v0, v0
    v_exp_f32 v1, v1
    v_fma_f32 v2, v2, s45, -v245
    v_fma_f32 v3, v3, s45, -v245
    s_waitcnt lgkmcnt(2)
    v_mfma_f32_16x16x32_bf16 v[80:83], v[208:211], v[180:183], v[80:83]
    v_max3_f32 v243, v243, v69, v70
    v_max3_f32 v244, v244, v77, v78
    v_max_f32 v243, v243, v71
    v_max_f32 v244, v244, v79
    v_exp_f32 v2, v2
    v_mfma_f32_16x16x32_bf16 v[88:91], v[208:211], v[188:191], v[88:91]
    ds_read_b128 v[196:199], v230 offset:14336
    s_add_u32 s46, s34, 6272
    buffer_load_dwordx4 v236, s[24:27], s46 offen offset:3072 lds
    v_exp_f32 v3, v3
    v_cvt_pk_bf16_f32 v0, v0, v1
    v_fma_f32 v4, v4, s45, -v245
    v_fma_f32 v5, v5, s45, -v245
    v_exp_f32 v4, v4
    s_waitcnt lgkmcnt(2)
    v_mfma_f32_16x16x32_bf16 v[84:87], v[212:215], v[180:183], v[84:87]
    v_exp_f32 v5, v5
    v_cvt_pk_bf16_f32 v1, v2, v3
    v_fma_f32 v6, v6, s45, -v245
    v_fma_f32 v7, v7, s45, -v245
    v_mfma_f32_16x16x32_bf16 v[92:95], v[212:215], v[188:191], v[92:95]
    ds_read_b128 v[200:203], v231 offset:12288
    v_exp_f32 v6, v6
    v_exp_f32 v7, v7
    v_cvt_pk_bf16_f32 v2, v4, v5
    v_fma_f32 v8, v8, s45, -v246
    v_fma_f32 v9, v9, s45, -v246
    s_waitcnt lgkmcnt(2)
    v_mfma_f32_16x16x32_bf16 v[96:99], v[192:195], v[176:179], v[96:99]
    v_exp_f32 v8, v8
    v_exp_f32 v9, v9
    v_cvt_pk_bf16_f32 v3, v6, v7
    v_fma_f32 v10, v10, s45, -v246
    v_fma_f32 v11, v11, s45, -v246
    v_mfma_f32_16x16x32_bf16 v[104:107], v[192:195], v[184:187], v[104:107]
    ds_read_b128 v[204:207], v231 offset:14336
    v_exp_f32 v10, v10
    v_exp_f32 v11, v11
    v_cvt_pk_bf16_f32 v4, v8, v9
    v_fma_f32 v12, v12, s45, -v246
    s_waitcnt lgkmcnt(2)
    v_mfma_f32_16x16x32_bf16 v[100:103], v[196:199], v[176:179], v[100:103]
    v_max3_f32 v243, v243, v80, v81
    v_max3_f32 v244, v244, v88, v89
    v_max3_f32 v243, v243, v82, v83
    v_max3_f32 v244, v244, v90, v91
    v_fma_f32 v13, v13, s45, -v246
    v_mfma_f32_16x16x32_bf16 v[108:111], v[196:199], v[184:187], v[108:111]
    ds_read_b128 v[208:211], v230 offset:0
    v_exp_f32 v12, v12
    v_exp_f32 v13, v13
    v_cvt_pk_bf16_f32 v5, v10, v11
    v_fma_f32 v14, v14, s45, -v246
    v_fma_f32 v15, v15, s45, -v246
    s_waitcnt lgkmcnt(2)
    v_mfma_f32_16x16x32_bf16 v[96:99], v[200:203], v[180:183], v[96:99]
    v_max3_f32 v243, v243, v84, v85
    v_max3_f32 v244, v244, v92, v93
    v_max3_f32 v243, v243, v86, v87
    v_max3_f32 v244, v244, v94, v95
    v_exp_f32 v14, v14
    v_mfma_f32_16x16x32_bf16 v[104:107], v[200:203], v[188:191], v[104:107]
    ds_read_b128 v[212:215], v230 offset:2048
    v_exp_f32 v15, v15
    v_cvt_pk_bf16_f32 v6, v12, v13
    v_cvt_pk_bf16_f32 v7, v14, v15
    v_fma_f32 v16, v16, s45, -v245
    v_fma_f32 v17, v17, s45, -v245
    s_waitcnt lgkmcnt(2)
    v_mfma_f32_16x16x32_bf16 v[100:103], v[204:207], v[180:183], v[100:103]
    v_exp_f32 v16, v16
    v_exp_f32 v17, v17
    v_fma_f32 v18, v18, s45, -v245
    v_fma_f32 v19, v19, s45, -v245
    v_mfma_f32_16x16x32_bf16 v[108:111], v[204:207], v[188:191], v[108:111]
    ds_read_b128 v[192:195], v231 offset:0
    v_exp_f32 v18, v18
    v_exp_f32 v19, v19
    v_cvt_pk_bf16_f32 v8, v16, v17
    v_fma_f32 v20, v20, s45, -v245
    v_fma_f32 v21, v21, s45, -v245
    s_waitcnt lgkmcnt(2)
    v_mfma_f32_16x16x32_bf16 v[112:115], v[208:211], v[176:179], v[112:115]
    v_exp_f32 v20, v20
    v_exp_f32 v21, v21
    v_cvt_pk_bf16_f32 v9, v18, v19
    v_fma_f32 v22, v22, s45, -v245
    v_fma_f32 v23, v23, s45, -v245
    ds_read_b128 v[196:199], v231 offset:2048
    v_exp_f32 v22, v22
    v_exp_f32 v23, v23
    v_cvt_pk_bf16_f32 v10, v20, v21
    v_fma_f32 v24, v24, s45, -v246
    s_waitcnt lgkmcnt(2)
    v_mfma_f32_16x16x32_bf16 v[116:119], v[212:215], v[176:179], v[116:119]
    v_max3_f32 v243, v243, v96, v97
    v_max3_f32 v244, v244, v104, v105
    v_max3_f32 v243, v243, v98, v99
    v_max3_f32 v244, v244, v106, v107
    v_fma_f32 v25, v25, s45, -v246
    v_mfma_f32_16x16x32_bf16 v[124:127], v[212:215], v[184:187], v[124:127]
    ds_read_b128 v[200:203], v230 offset:16384
    v_exp_f32 v24, v24
    v_exp_f32 v25, v25
    v_cvt_pk_bf16_f32 v11, v22, v23
    v_fma_f32 v26, v26, s45, -v246
    v_fma_f32 v27, v27, s45, -v246
    s_waitcnt lgkmcnt(2)
    v_mfma_f32_16x16x32_bf16 v[112:115], v[192:195], v[180:183], v[112:115]
    v_max3_f32 v243, v243, v100, v101
    v_max3_f32 v244, v244, v108, v109
    v_max3_f32 v243, v243, v102, v103
    v_max3_f32 v244, v244, v110, v111
    v_exp_f32 v26, v26
    ds_read_b128 v[204:207], v230 offset:18432
    v_exp_f32 v27, v27
    v_cvt_pk_bf16_f32 v12, v24, v25
    v_fma_f32 v28, v28, s45, -v246
    v_fma_f32 v29, v29, s45, -v246
    v_exp_f32 v28, v28
    s_waitcnt lgkmcnt(2)
    v_mfma_f32_16x16x32_bf16 v[116:119], v[196:199], v[180:183], v[116:119]
    v_exp_f32 v29, v29
    v_cvt_pk_bf16_f32 v13, v26, v27
    v_fma_f32 v30, v30, s45, -v246
    v_fma_f32 v31, v31, s45, -v246
    v_exp_f32 v30, v30
    v_mfma_f32_16x16x32_bf16 v[124:127], v[196:199], v[188:191], v[124:127]
    ds_read_b128 v[208:211], v231 offset:16384
    v_exp_f32 v31, v31
    v_cvt_pk_bf16_f32 v14, v28, v29
    v_cvt_pk_bf16_f32 v15, v30, v31
    v_fma_f32 v32, v32, s45, -v245
    v_fma_f32 v33, v33, s45, -v245
    s_waitcnt lgkmcnt(2)
    v_mfma_f32_16x16x32_bf16 v[128:131], v[200:203], v[176:179], v[128:131]
    v_exp_f32 v32, v32
    v_exp_f32 v33, v33
    v_fma_f32 v34, v34, s45, -v245
    v_fma_f32 v35, v35, s45, -v245
    v_mfma_f32_16x16x32_bf16 v[136:139], v[200:203], v[184:187], v[136:139]
    ds_read_b128 v[212:215], v231 offset:18432
    v_exp_f32 v34, v34
    v_exp_f32 v35, v35
    v_cvt_pk_bf16_f32 v32, v32, v33
    v_fma_f32 v36, v36, s45, -v245
    v_fma_f32 v37, v37, s45, -v245
    s_waitcnt lgkmcnt(2)
    v_mfma_f32_16x16x32_bf16 v[140:143], v[204:207], v[184:187], v[140:143]
    v_max3_f32 v243, v243, v112, v113
    v_exp_f32 v36, v36
    s_waitcnt vmcnt(4)
    s_barrier
    v_add_u32 v230, 49152, v226
    v_add_u32 v231, 49152, v227
    v_add_u32 v232, 49152, v228
    v_add_u32 v233, 49152, v229
    ds_read_b64_tr_b16 v[192:193], v230 offset:0
    ds_read_b64_tr_b16 v[194:195], v230 offset:2048
    s_add_u32 m0, s35, 98304
    s_add_u32 s46, s34, 49152
    buffer_load_dwordx4 v236, s[24:27], s46 offen offset:0 lds
    v_exp_f32 v37, v37
    v_cvt_pk_bf16_f32 v33, v34, v35
    v_fma_f32 v38, v38, s45, -v245
    v_fma_f32 v39, v39, s45, -v245
    s_waitcnt lgkmcnt(3)
    v_mfma_f32_16x16x32_bf16 v[128:131], v[208:211], v[180:183], v[128:131]
    v_max3_f32 v244, v244, v124, v125
    v_max3_f32 v243, v243, v114, v115
    v_max3_f32 v244, v244, v126, v127
    v_max3_f32 v243, v243, v116, v117
    v_max3_f32 v243, v243, v118, v119
    v_mfma_f32_16x16x32_bf16 v[136:139], v[208:211], v[188:191], v[136:139]
    ds_read_b64_tr_b16 v[196:197], v231 offset:0
    ds_read_b64_tr_b16 v[198:199], v231 offset:2048
    v_exp_f32 v38, v38
    v_exp_f32 v39, v39
    v_cvt_pk_bf16_f32 v34, v36, v37
    v_fma_f32 v40, v40, s45, -v246
    v_fma_f32 v41, v41, s45, -v246
    s_waitcnt lgkmcnt(4)
    v_mfma_f32_16x16x32_bf16 v[140:143], v[212:215], v[188:191], v[140:143]
    v_exp_f32 v40, v40
    v_exp_f32 v41, v41
    v_cvt_pk_bf16_f32 v35, v38, v39
    v_fma_f32 v42, v42, s45, -v246
    v_fma_f32 v43, v43, s45, -v246
    ds_read_b64_tr_b16 v[200:201], v232 offset:0
    ds_read_b64_tr_b16 v[202:203], v232 offset:2048
    v_exp_f32 v42, v42
    v_exp_f32 v43, v43
    v_cvt_pk_bf16_f32 v36, v40, v41
    v_fma_f32 v44, v44, s45, -v246
    s_waitcnt lgkmcnt(4)
    v_mfma_f32_16x16x32_bf16 v[144:147], v[192:195], v[0:3], 0
    v_fma_f32 v45, v45, s45, -v246
    v_exp_f32 v44, v44
    v_mfma_f32_16x16x32_bf16 v[160:163], v[192:195], v[4:7], 0
    ds_read_b64_tr_b16 v[204:205], v233 offset:0
    ds_read_b64_tr_b16 v[206:207], v233 offset:2048
    s_add_u32 s46, s34, 51200
    buffer_load_dwordx4 v236, s[24:27], s46 offen offset:1024 lds
    v_exp_f32 v45, v45
    v_cvt_pk_bf16_f32 v37, v42, v43
    v_fma_f32 v46, v46, s45, -v246
    v_fma_f32 v47, v47, s45, -v246
    s_waitcnt lgkmcnt(4)
    v_mfma_f32_16x16x32_bf16 v[148:151], v[196:199], v[0:3], 0
    v_max3_f32 v243, v243, v128, v129
    v_max3_f32 v244, v244, v136, v137
    v_max3_f32 v243, v243, v130, v131
    v_exp_f32 v46, v46
    v_mfma_f32_16x16x32_bf16 v[164:167], v[196:199], v[4:7], 0
    ds_read_b64_tr_b16 v[208:209], v230 offset:4096
    ds_read_b64_tr_b16 v[210:211], v230 offset:6144
    v_exp_f32 v47, v47
    v_cvt_pk_bf16_f32 v38, v44, v45
    v_cvt_pk_bf16_f32 v39, v46, v47
    s_waitcnt lgkmcnt(4)
    v_mfma_f32_16x16x32_bf16 v[152:155], v[200:203], v[0:3], 0
    v_max3_f32 v244, v244, v138, v139
    v_max3_f32 v244, v244, v140, v141
    v_max3_f32 v244, v244, v142, v143
    v_fma_f32 v48, v48, s45, -v245
    v_fma_f32 v49, v49, s45, -v245
    v_mfma_f32_16x16x32_bf16 v[168:171], v[200:203], v[4:7], 0
    ds_read_b64_tr_b16 v[212:213], v231 offset:4096
    ds_read_b64_tr_b16 v[214:215], v231 offset:6144
    v_exp_f32 v48, v48
    v_exp_f32 v49, v49
    s_waitcnt lgkmcnt(4)
    v_mfma_f32_16x16x32_bf16 v[156:159], v[204:207], v[0:3], 0
    v_permlane32_swap_b32 v243, v244
    v_max_f32 v243, v243, v244
    v_mov_b32 v244, v243
    s_nop 1
    v_permlane16_swap_b32 v243, v244
    v_mfma_f32_16x16x32_bf16 v[172:175], v[204:207], v[4:7], 0
    ds_read_b64_tr_b16 v[192:193], v232 offset:4096
    ds_read_b64_tr_b16 v[194:195], v232 offset:6144
    s_add_u32 s46, s34, 53248
    buffer_load_dwordx4 v236, s[24:27], s46 offen offset:2048 lds
    v_fma_f32 v50, v50, s45, -v245
    v_fma_f32 v51, v51, s45, -v245
    v_exp_f32 v50, v50
    s_waitcnt lgkmcnt(4)
    v_mfma_f32_16x16x32_bf16 v[144:147], v[208:211], v[8:11], v[144:147]
    v_max_f32 v243, v243, v244
    v_mov_b32 v244, v243
    s_nop 1
    v_permlane32_swap_b32 v243, v244
    v_mfma_f32_16x16x32_bf16 v[160:163], v[208:211], v[12:15], v[160:163]
    ds_read_b64_tr_b16 v[196:197], v233 offset:4096
    ds_read_b64_tr_b16 v[198:199], v233 offset:6144
    v_sub_f32 v251, v243, v241
    v_sub_f32 v254, v244, v242
    v_max_f32 v251, v251, v254
    v_cmp_lt_f32 vcc, 0x4319ac27, v251
    s_nop 1
    s_cmp_lg_u64 vcc, 0
    s_cbranch_scc1 L_rare_mh
L_back_mh:
    s_waitcnt lgkmcnt(4)
    v_mfma_f32_16x16x32_bf16 v[148:151], v[212:215], v[8:11], v[148:151]
    v_exp_f32 v51, v51
    v_cvt_pk_bf16_f32 v40, v48, v49
    v_fma_f32 v52, v52, s45, -v245
    v_fma_f32 v53, v53, s45, -v245
    v_mfma_f32_16x16x32_bf16 v[164:167], v[212:215], v[12:15], v[164:167]
    ds_read_b64_tr_b16 v[200:201], v230 offset:8192
    ds_read_b64_tr_b16 v[202:203], v230 offset:10240
    v_exp_f32 v52, v52
    v_exp_f32 v53, v53
    s_waitcnt lgkmcnt(4)
    v_mfma_f32_16x16x32_bf16 v[152:155], v[192:195], v[8:11], v[152:155]
    v_cvt_pk_bf16_f32 v41, v50, v51
    v_fma_f32 v54, v54, s45, -v245
    v_fma_f32 v55, v55, s45, -v245
    v_exp_f32 v54, v54
    v_mfma_f32_16x16x32_bf16 v[168:171], v[192:195], v[12:15], v[168:171]
    ds_read_b64_tr_b16 v[204:205], v231 offset:8192
    ds_read_b64_tr_b16 v[206:207], v231 offset:10240
    s_add_u32 s46, s34, 55296
    buffer_load_dwordx4 v236, s[24:27], s46 offen offset:3072 lds
    v_exp_f32 v55, v55
    v_cvt_pk_bf16_f32 v42, v52, v53
    v_fma_f32 v56, v56, s45, -v246
    s_waitcnt lgkmcnt(4)
    v_mfma_f32_16x16x32_bf16 v[156:159], v[196:199], v[8:11], v[156:159]
    v_fma_f32 v57, v57, s45, -v246
    v_exp_f32 v56, v56
    v_mfma_f32_16x16x32_bf16 v[172:175], v[196:199], v[12:15], v[172:175]
    ds_read_b64_tr_b16 v[208:209], v232 offset:8192
    ds_read_b64_tr_b16 v[210:211], v232 offset:10240
    v_exp_f32 v57, v57
    v_cvt_pk_bf16_f32 v43, v54, v55
    v_fma_f32 v58, v58, s45, -v246
    v_fma_f32 v59, v59, s45, -v246
    s_waitcnt lgkmcnt(4)
    v_mfma_f32_16x16x32_bf16 v[144:147], v[200:203], v[32:35], v[144:147]
    v_exp_f32 v58, v58
    v_exp_f32 v59, v59
    v_cvt_pk_bf16_f32 v44, v56, v57
    v_mfma_f32_16x16x32_bf16 v[160:163], v[200:203], v[36:39], v[160:163]
    ds_read_b64_tr_b16 v[212:213], v233 offset:8192
    ds_read_b64_tr_b16 v[214:215], v233 offset:10240
    v_fma_f32 v60, v60, s45, -v246
    v_fma_f32 v61, v61, s45, -v246
    v_exp_f32 v60, v60
    s_waitcnt lgkmcnt(4)
    v_mfma_f32_16x16x32_bf16 v[148:151], v[204:207], v[32:35], v[148:151]
    v_exp_f32 v61, v61
    v_cvt_pk_bf16_f32 v45, v58, v59
    v_fma_f32 v62, v62, s45, -v246
    v_fma_f32 v63, v63, s45, -v246
    v_mfma_f32_16x16x32_bf16 v[164:167], v[204:207], v[36:39], v[164:167]
    ds_read_b64_tr_b16 v[192:193], v230 offset:12288
    ds_read_b64_tr_b16 v[194:195], v230 offset:14336
    s_add_u32 m0, s35, 131072
    s_add_u32 s46, s34, 49280
    buffer_load_dwordx4 v236, s[24:27], s46 offen offset:0 lds
    v_exp_f32 v62, v62
    v_exp_f32 v63, v63
    s_waitcnt lgkmcnt(4)
    v_mfma_f32_16x16x32_bf16 v[152:155], v[208:211], v[32:35], v[152:155]
    v_cvt_pk_bf16_f32 v46, v60, v61
    v_cvt_pk_bf16_f32 v47, v62, v63
    v_fma_f32 v64, v64, s45, -v247
    v_mfma_f32_16x16x32_bf16 v[168:171], v[208:211], v[36:39], v[168:171]
    ds_read_b64_tr_b16 v[196:197], v231 offset:12288
    ds_read_b64_tr_b16 v[198:199], v231 offset:14336
    v_fma_f32 v65, v65, s45, -v247
    v_exp_f32 v64, v64
    s_waitcnt lgkmcnt(4)
    v_mfma_f32_16x16x32_bf16 v[156:159], v[212:215], v[32:35], v[156:159]
    v_exp_f32 v65, v65
    v_fma_f32 v66, v66, s45, -v247
    v_mfma_f32_16x16x32_bf16 v[172:175], v[212:215], v[36:39], v[172:175]
    ds_read_b64_tr_b16 v[200:201], v232 offset:12288
    ds_read_b64_tr_b16 v[202:203], v232 offset:14336
    v_fma_f32 v67, v67, s45, -v247
    v_exp_f32 v66, v66
    s_waitcnt lgkmcnt(4)
    v_mfma_f32_16x16x32_bf16 v[144:147], v[192:195], v[40:43], v[144:147]
    v_exp_f32 v67, v67
    v_cvt_pk_bf16_f32 v64, v64, v65
    v_mfma_f32_16x16x32_bf16 v[160:163], v[192:195], v[44:47], v[160:163]
    ds_read_b64_tr_b16 v[204:205], v233 offset:12288
    ds_read_b64_tr_b16 v[206:207], v233 offset:14336
    s_add_u32 s46, s34, 51328
    buffer_load_dwordx4 v236, s[24:27], s46 offen offset:1024 lds
    v_fma_f32 v68, v68, s45, -v247
    v_fma_f32 v69, v69, s45, -v247
    s_waitcnt lgkmcnt(4)
    v_mfma_f32_16x16x32_bf16 v[148:151], v[196:199], v[40:43], v[148:151]
    v_mfma_f32_16x16x32_bf16 v[164:167], v[196:199], v[44:47], v[164:167]
    s_add_u32 s46, s34, 53376
    buffer_load_dwordx4 v236, s[24:27], s46 offen offset:2048 lds
    s_add_u32 s46, s34, 55424
    buffer_load_dwordx4 v236, s[24:27], s46 offen offset:3072 lds
    s_waitcnt vmcnt(8)
    s_barrier
    v_add_u32 v230, 81920, v226
    v_add_u32 v231, 81920, v227
    v_add_u32 v232, 81920, v228
    v_add_u32 v233, 81920, v229
    ds_read_b64_tr_b16 v[208:209], v230 offset:0
    ds_read_b64_tr_b16 v[210:211], v230 offset:2048
    s_add_u32 m0, s35, 0
    s_add_u32 s46, s34, 256
    buffer_load_dwordx4 v236, s[24:27], s46 offen offset:0 lds
    v_exp_f32 v68, v68
    s_waitcnt lgkmcnt(4)
    v_mfma_f32_16x16x32_bf16 v[152:155], v[200:203], v[40:43], v[152:155]
    v_exp_f32 v69, v69
    v_cvt_pk_bf16_f32 v65, v66, v67
    v_mfma_f32_16x16x32_bf16 v[168:171], v[200:203], v[44:47], v[168:171]
    ds_read_b64_tr_b16 v[212:213], v231 offset:0
    ds_read_b64_tr_b16 v[214:215], v231 offset:2048
    v_fma_f32 v70, v70, s45, -v247
    v_fma_f32 v71, v71, s45, -v247
    s_waitcnt lgkmcnt(4)
    v_mfma_f32_16x16x32_bf16 v[156:159], v[204:207], v[40:43], v[156:159]
    v_exp_f32 v70, v70
    v_mfma_f32_16x16x32_bf16 v[172:175], v[204:207], v[44:47], v[172:175]
    ds_read_b64_tr_b16 v[192:193], v232 offset:0
    ds_read_b64_tr_b16 v[194:195], v232 offset:2048
    v_exp_f32 v71, v71
    v_cvt_pk_bf16_f32 v66, v68, v69
    v_fma_f32 v72, v72, s45, -v248
    s_waitcnt lgkmcnt(4)
    v_mfma_f32_16x16x32_bf16 v[176:179], v[208:211], v[0:3], 0
    v_fma_f32 v73, v73, s45, -v248
    v_exp_f32 v72, v72
    v_mfma_f32_16x16x32_bf16 v[48:51], v[208:211], v[4:7], 0
    ds_read_b64_tr_b16 v[196:197], v233 offset:0
    ds_read_b64_tr_b16 v[198:199], v233 offset:2048
    s_add_u32 s46, s34, 2304
    buffer_load_dwordx4 v236, s[24:27], s46 offen offset:1024 lds
    v_exp_f32 v73, v73
    v_cvt_pk_bf16_f32 v67, v70, v71
    s_waitcnt lgkmcnt(4)
    v_mfma_f32_16x16x32_bf16 v[180:183], v[212:215], v[0:3], 0
    v_fma_f32 v74, v74, s45, -v248
    v_fma_f32 v75, v75, s45, -v248
    v_mfma_f32_16x16x32_bf16 v[52:55], v[212:215], v[4:7], 0
    v_exp_f32 v74, v74
    v_exp_f32 v75, v75
    s_waitcnt lgkmcnt(2)
    v_mfma_f32_16x16x32_bf16 v[184:187], v[192:195], v[0:3], 0
    v_cvt_pk_bf16_f32 v68, v72, v73
    v_fma_f32 v76, v76, s45, -v248
    v_fma_f32 v77, v77, s45, -v248
    v_mfma_f32_16x16x32_bf16 v[56:59], v[192:195], v[4:7], 0
    ds_read_b64_tr_b16 v[200:201], v230 offset:4096
    ds_read_b64_tr_b16 v[202:203], v230 offset:6144
    v_exp_f32 v76, v76
    s_waitcnt lgkmcnt(2)
    v_mfma_f32_16x16x32_bf16 v[188:191], v[196:199], v[0:3], 0
    v_exp_f32 v77, v77
    v_cvt_pk_bf16_f32 v69, v74, v75
    v_mfma_f32_16x16x32_bf16 v[60:63], v[196:199], v[4:7], 0
    ds_read_b64_tr_b16 v[204:205], v231 offset:4096
    ds_read_b64_tr_b16 v[206:207], v231 offset:6144
    s_add_u32 s46, s34, 4352
    buffer_load_dwordx4 v236, s[24:27], s46 offen offset:2048 lds
    v_fma_f32 v78, v78, s45, -v248
    v_fma_f32 v79, v79, s45, -v248
    v_mfma_f32_16x16x32_bf16 v[16:19], v[220:223], v[0:3], 0
    v_exp_f32 v78, v78
    v_exp_f32 v79, v79
    v_cvt_pk_bf16_f32 v70, v76, v77
    v_mfma_f32_16x16x32_bf16 v[20:23], v[220:223], v[4:7], 0
    ds_read_b64_tr_b16 v[208:209], v232 offset:4096
    ds_read_b64_tr_b16 v[210:211], v232 offset:6144
    v_cvt_pk_bf16_f32 v71, v78, v79
    v_fma_f32 v80, v80, s45, -v247
    v_fma_f32 v81, v81, s45, -v247
    v_exp_f32 v80, v80
    s_waitcnt lgkmcnt(4)
    v_mfma_f32_16x16x32_bf16 v[176:179], v[200:203], v[8:11], v[176:179]
    v_exp_f32 v81, v81
    v_fma_f32 v82, v82, s45, -v247
    v_mfma_f32_16x16x32_bf16 v[48:51], v[200:203], v[12:15], v[48:51]
    ds_read_b64_tr_b16 v[212:213], v233 offset:4096
    ds_read_b64_tr_b16 v[214:215], v233 offset:6144
    v_fma_f32 v83, v83, s45, -v247
    v_exp_f32 v82, v82
    s_waitcnt lgkmcnt(4)
    v_mfma_f32_16x16x32_bf16 v[180:183], v[204:207], v[8:11], v[180:183]
    v_exp_f32 v83, v83
    v_cvt_pk_bf16_f32 v72, v80, v81
    v_mfma_f32_16x16x32_bf16 v[52:55], v[204:207], v[12:15], v[52:55]
    s_add_u32 s46, s34, 6400
    buffer_load_dwordx4 v236, s[24:27], s46 offen offset:3072 lds
    v_fma_f32 v84, v84, s45, -v247
    v_fma_f32 v85, v85, s45, -v247
    s_waitcnt lgkmcnt(2)
    v_mfma_f32_16x16x32_bf16 v[184:187], v[208:211], v[8:11], v[184:187]
    v_exp_f32 v84, v84
    v_mfma_f32_16x16x32_bf16 v[56:59], v[208:211], v[12:15], v[56:59]
    ds_read_b64_tr_b16 v[192:193], v230 offset:8192
    ds_read_b64_tr_b16 v[194:195], v230 offset:10240
    v_exp_f32 v85, v85
    v_cvt_pk_bf16_f32 v73, v82, v83
    v_fma_f32 v86, v86, s45, -v247
    s_waitcnt lgkmcnt(2)
    v_mfma_f32_16x16x32_bf16 v[188:191], v[212:215], v[8:11], v[188:191]
    v_fma_f32 v87, v87, s45, -v247
    v_exp_f32 v86, v86
    v_mfma_f32_16x16x32_bf16 v[60:63], v[212:215], v[12:15], v[60:63]
    ds_read_b64_tr_b16 v[196:197], v231 offset:8192
    ds_read_b64_tr_b16 v[198:199], v231 offset:10240
    v_exp_f32 v87, v87
    v_cvt_pk_bf16_f32 v74, v84, v85
    v_mfma_f32_16x16x32_bf16 v[16:19], v[220:223], v[8:11], v[16:19]
    v_fma_f32 v88, v88, s45, -v248
    v_fma_f32 v89, v89, s45, -v248
    v_exp_f32 v88, v88
    v_exp_f32 v89, v89
    v_mfma_f32_16x16x32_bf16 v[20:23], v[220:223], v[12:15], v[20:23]
    ds_read_b64_tr_b16 v[200:201], v232 offset:8192
    ds_read_b64_tr_b16 v[202:203], v232 offset:10240
    v_cvt_pk_bf16_f32 v75, v86, v87
    v_fma_f32 v90, v90, s45, -v248
    v_fma_f32 v91, v91, s45, -v248
    v_exp_f32 v90, v90
    s_waitcnt lgkmcnt(4)
    v_mfma_f32_16x16x32_bf16 v[176:179], v[192:195], v[32:35], v[176:179]
    v_exp_f32 v91, v91
    v_cvt_pk_bf16_f32 v76, v88, v89
    v_mfma_f32_16x16x32_bf16 v[48:51], v[192:195], v[36:39], v[48:51]
    ds_read_b64_tr_b16 v[204:205], v233 offset:8192
    ds_read_b64_tr_b16 v[206:207], v233 offset:10240
    v_fma_f32 v92, v92, s45, -v248
    v_fma_f32 v93, v93, s45, -v248
    s_waitcnt lgkmcnt(4)
    v_mfma_f32_16x16x32_bf16 v[180:183], v[196:199], v[32:35], v[180:183]
    v_exp_f32 v92, v92
    v_mfma_f32_16x16x32_bf16 v[52:55], v[196:199], v[36:39], v[52:55]
    v_exp_f32 v93, v93
    v_cvt_pk_bf16_f32 v77, v90, v91
    v_fma_f32 v94, v94, s45, -v248
    s_waitcnt lgkmcnt(2)
    v_mfma_f32_16x16x32_bf16 v[184:187], v[200:203], v[32:35], v[184:187]
    v_fma_f32 v95, v95, s45, -v248
    v_exp_f32 v94, v94
    v_mfma_f32_16x16x32_bf16 v[56:59], v[200:203], v[36:39], v[56:59]
    ds_read_b64_tr_b16 v[208:209], v230 offset:12288
    ds_read_b64_tr_b16 v[210:211], v230 offset:14336
    v_exp_f32 v95, v95
    v_cvt_pk_bf16_f32 v78, v92, v93
    s_waitcnt lgkmcnt(2)
    v_mfma_f32_16x16x32_bf16 v[188:191], v[204:207], v[32:35], v[188:191]
    v_cvt_pk_bf16_f32 v79, v94, v95
    v_fma_f32 v96, v96, s45, -v247
    v_fma_f32 v97, v97, s45, -v247
    v_mfma_f32_16x16x32_bf16 v[60:63], v[204:207], v[36:39], v[60:63]
    ds_read_b64_tr_b16 v[212:213], v231 offset:12288
    ds_read_b64_tr_b16 v[214:215], v231 offset:14336
    v_exp_f32 v96, v96
    v_mfma_f32_16x16x32_bf16 v[16:19], v[220:223], v[32:35], v[16:19]
    v_exp_f32 v97, v97
    v_fma_f32 v98, v98, s45, -v247
    v_fma_f32 v99, v99, s45, -v247
    v_exp_f32 v98, v98
    v_mfma_f32_16x16x32_bf16 v[20:23], v[220:223], v[36:39], v[20:23]
    ds_read_b64_tr_b16 v[192:193], v232 offset:12288
    ds_read_b64_tr_b16 v[194:195], v232 offset:14336
    v_exp_f32 v99, v99
    v_cvt_pk_bf16_f32 v96, v96, v97
    v_fma_f32 v100, v100, s45, -v247
    v_fma_f32 v101, v101, s45, -v247
    s_waitcnt lgkmcnt(4)
    v_mfma_f32_16x16x32_bf16 v[176:179], v[208:211], v[40:43], v[176:179]
    v_exp_f32 v100, v100
    v_mfma_f32_16x16x32_bf16 v[48:51], v[208:211], v[44:47], v[48:51]
    ds_read_b64_tr_b16 v[196:197], v233 offset:12288
    ds_read_b64_tr_b16 v[198:199], v233 offset:14336
    v_exp_f32 v101, v101
    v_cvt_pk_bf16_f32 v97, v98, v99
    v_fma_f32 v102, v102, s45, -v247
    s_waitcnt lgkmcnt(4)
    v_mfma_f32_16x16x32_bf16 v[180:183], v[212:215], v[40:43], v[180:183]
    v_fma_f32 v103, v103, s45, -v247
    v_exp_f32 v102, v102
    v_mfma_f32_16x16x32_bf16 v[52:55], v[212:215], v[44:47], v[52:55]
    v_exp_f32 v103, v103
    v_cvt_pk_bf16_f32 v98, v100, v101
    s_waitcnt lgkmcnt(2)
    v_mfma_f32_16x16x32_bf16 v[184:187], v[192:195], v[40:43], v[184:187]
    v_fma_f32 v104, v104, s45, -v248
    v_mfma_f32_16x16x32_bf16 v[56:59], v[192:195], v[44:47], v[56:59]
    s_waitcnt vmcnt(8)
    s_barrier
    s_add_u32 s47, s36, 98304
    v_add_u32 v230, s47, v226
    v_add_u32 v231, s47, v227
    v_add_u32 v232, s47, v228
    v_add_u32 v233, s47, v229
    ds_read_b64_tr_b16 v[200:201], v230 offset:4096
    ds_read_b64_tr_b16 v[202:203], v230 offset:6144
    s_add_u32 m0, s35, 32768
    s_add_u32 s46, s34, 49408
    buffer_load_dwordx4 v236, s[24:27], s46 offen offset:0 lds
    v_fma_f32 v105, v105, s45, -v248
    s_waitcnt lgkmcnt(2)
    v_mfma_f32_16x16x32_bf16 v[188:191], v[196:199], v[40:43], v[188:191]
    v_exp_f32 v104, v104
    v_mfma_f32_16x16x32_bf16 v[60:63], v[196:199], v[44:47], v[60:63]
    ds_read_b64_tr_b16 v[204:205], v231 offset:4096
    ds_read_b64_tr_b16 v[206:207], v231 offset:6144
    v_exp_f32 v105, v105
    v_cvt_pk_bf16_f32 v99, v102, v103
    v_fma_f32 v106, v106, s45, -v248
    v_mfma_f32_16x16x32_bf16 v[16:19], v[220:223], v[40:43], v[16:19]
    v_fma_f32 v107, v107, s45, -v248
    v_exp_f32 v106, v106
    v_exp_f32 v107, v107
    v_mfma_f32_16x16x32_bf16 v[20:23], v[220:223], v[44:47], v[20:23]
    ds_read_b64_tr_b16 v[208:209], v232 offset:4096
    ds_read_b64_tr_b16 v[210:211], v232 offset:6144
    v_cvt_pk_bf16_f32 v100, v104, v105
    v_fma_f32 v108, v108, s45, -v248
    v_fma_f32 v109, v109, s45, -v248
    v_exp_f32 v108, v108
    s_cmp_lg_u32 s54, 0
    s_cbranch_scc1 L_rare_h0
L_back_h0:
    s_waitcnt lgkmcnt(4)
    v_mfma_f32_16x16x32_bf16 v[144:147], v[200:203], v[64:67], v[144:147]
    v_exp_f32 v109, v109
    v_cvt_pk_bf16_f32 v101, v106, v107
    v_mfma_f32_16x16x32_bf16 v[160:163], v[200:203], v[68:71], v[160:163]
    ds_read_b64_tr_b16 v[212:213], v233 offset:4096
    ds_read_b64_tr_b16 v[214:215], v233 offset:6144
    s_add_u32 s46, s34, 51456
    buffer_load_dwordx4 v236, s[24:27], s46 offen offset:1024 lds
    v_fma_f32 v110, v110, s45, -v248
    v_fma_f32 v111, v111, s45, -v248
    s_waitcnt lgkmcnt(4)
    v_mfma_f32_16x16x32_bf16 v[148:151], v[204:207], v[64:67], v[148:151]
    v_exp_f32 v110, v110
    v_mfma_f32_16x16x32_bf16 v[164:167], v[204:207], v[68:71], v[164:167]
    v_exp_f32 v111, v111
    v_cvt_pk_bf16_f32 v102, v108, v109
    v_cvt_pk_bf16_f32 v103, v110, v111
    s_waitcnt lgkmcnt(2)
    v_mfma_f32_16x16x32_bf16 v[152:155], v[208:211], v[64:67], v[152:155]
    v_fma_f32 v112, v112, s45, -v247
    v_fma_f32 v113, v113, s45, -v247
    v_mfma_f32_16x16x32_bf16 v[168:171], v[208:211], v[68:71], v[168:171]
    ds_read_b64_tr_b16 v[192:193], v230 offset:8192
    ds_read_b64_tr_b16 v[194:195], v230 offset:10240
    v_exp_f32 v112, v112
    v_exp_f32 v113, v113
    s_waitcnt lgkmcnt(2)
    v_mfma_f32_16x16x32_bf16 v[156:159], v[212:215], v[64:67], v[156:159]
    v_fma_f32 v114, v114, s45, -v247
    v_fma_f32 v115, v115, s45, -v247
    v_mfma_f32_16x16x32_bf16 v[172:175], v[212:215], v[68:71], v[172:175]
    ds_read_b64_tr_b16 v[196:197], v231 offset:8192
    ds_read_b64_tr_b16 v[198:199], v231 offset:10240
    s_add_u32 s46, s34, 53504
    buffer_load_dwordx4 v236, s[24:27], s46 offen offset:2048 lds
    v_exp_f32 v114, v114
    v_exp_f32 v115, v115
    v_mfma_f32_16x16x32_bf16 v[16:19], v[220:223], v[64:67], v[16:19]
    v_cvt_pk_bf16_f32 v104, v112, v113
    v_fma_f32 v116, v116, s45, -v247
    v_fma_f32 v117, v117, s45, -v247
    v_exp_f32 v116, v116
    v_mfma_f32_16x16x32_bf16 v[20:23], v[220:223], v[68:71], v[20:23]
    ds_read_b64_tr_b16 v[200:201], v232 offset:8192
    ds_read_b64_tr_b16 v[202:203], v232 offset:10240
    v_exp_f32 v117, v117
    v_cvt_pk_bf16_f32 v105, v114, v115
    v_fma_f32 v118, v118, s45, -v247
    v_fma_f32 v119, v119, s45, -v247
    s_waitcnt lgkmcnt(4)
    v_mfma_f32_16x16x32_bf16 v[144:147], v[192:195], v[72:75], v[144:147]
    v_exp_f32 v118, v118
    v_mfma_f32_16x16x32_bf16 v[160:163], v[192:195], v[76:79], v[160:163]
    ds_read_b64_tr_b16 v[204:205], v233 offset:8192
    ds_read_b64_tr_b16 v[206:207], v233 offset:10240
    v_exp_f32 v119, v119
    v_cvt_pk_bf16_f32 v106, v116, v117
    v_cvt_pk_bf16_f32 v107, v118, v119
    s_waitcnt lgkmcnt(4)
    v_mfma_f32_16x16x32_bf16 v[148:151], v[196:199], v[72:75], v[148:151]
    v_mov_b32 v108, 0
    v_fma_f32 v124, v124, s45, -v248
    v_fma_f32 v125, v125, s45, -v248
    v_mfma_f32_16x16x32_bf16 v[164:167], v[196:199], v[76:79], v[164:167]
    s_add_u32 s46, s34, 55552
    buffer_load_dwordx4 v236, s[24:27], s46 offen offset:3072 lds
    v_exp_f32 v124, v124
    s_waitcnt lgkmcnt(2)
    v_mfma_f32_16x16x32_bf16 v[152:155], v[200:203], v[72:75], v[152:155]
    v_exp_f32 v125, v125
    v_mov_b32 v109, 0
    v_mfma_f32_16x16x32_bf16 v[168:171], v[200:203], v[76:79], v[168:171]
    ds_read_b64_tr_b16 v[208:209], v230 offset:12288
    ds_read_b64_tr_b16 v[210:211], v230 offset:14336
    v_fma_f32 v126, v126, s45, -v248
    v_fma_f32 v127, v127, s45, -v248
    s_waitcnt lgkmcnt(2)
    v_mfma_f32_16x16x32_bf16 v[156:159], v[204:207], v[72:75], v[156:159]
    v_exp_f32 v126, v126
    v_mfma_f32_16x16x32_bf16 v[172:175], v[204:207], v[76:79], v[172:175]
    ds_read_b64_tr_b16 v[212:213], v231 offset:12288
    ds_read_b64_tr_b16 v[214:215], v231 offset:14336
    v_exp_f32 v127, v127
    v_cvt_pk_bf16_f32 v110, v124, v125
    v_cvt_pk_bf16_f32 v111, v126, v127
    v_mfma_f32_16x16x32_bf16 v[16:19], v[220:223], v[72:75], v[16:19]
    v_fma_f32 v128, v128, s45, -v247
    v_fma_f32 v129, v129, s45, -v247
    v_exp_f32 v128, v128
    v_mfma_f32_16x16x32_bf16 v[20:23], v[220:223], v[76:79], v[20:23]
    ds_read_b64_tr_b16 v[192:193], v232 offset:12288
    ds_read_b64_tr_b16 v[194:195], v232 offset:14336
    v_exp_f32 v129, v129
    v_fma_f32 v130, v130, s45, -v247
    v_fma_f32 v131, v131, s45, -v247
    v_exp_f32 v130, v130
    s_waitcnt lgkmcnt(4)
    v_mfma_f32_16x16x32_bf16 v[144:147], v[208:211], v[96:99], v[144:147]
    v_exp_f32 v131, v131
    v_cvt_pk_bf16_f32 v128, v128, v129
    v_mfma_f32_16x16x32_bf16 v[160:163], v[208:211], v[100:103], v[160:163]
    ds_read_b64_tr_b16 v[196:197], v233 offset:12288
    ds_read_b64_tr_b16 v[198:199], v233 offset:14336
    v_cvt_pk_bf16_f32 v129, v130, v131
    v_mov_b32 v130, 0
    v_fma_f32 v136, v136, s45, -v248
    s_waitcnt lgkmcnt(4)
    v_mfma_f32_16x16x32_bf16 v[148:151], v[212:215], v[96:99], v[148:151]
    v_fma_f32 v137, v137, s45, -v248
    v_exp_f32 v136, v136
    v_mfma_f32_16x16x32_bf16 v[164:167], v[212:215], v[100:103], v[164:167]
    v_exp_f32 v137, v137
    v_mov_b32 v131, 0
    s_waitcnt lgkmcnt(2)
    v_mfma_f32_16x16x32_bf16 v[152:155], v[192:195], v[96:99], v[152:155]
    v_fma_f32 v138, v138, s45, -v248
    v_fma_f32 v139, v139, s45, -v248
    v_mfma_f32_16x16x32_bf16 v[168:171], v[192:195], v[100:103], v[168:171]
    ds_read_b64_tr_b16 v[200:201], v230 offset:0
    ds_read_b64_tr_b16 v[202:203], v230 offset:2048
    v_exp_f32 v138, v138
    v_exp_f32 v139, v139
    s_waitcnt lgkmcnt(2)
    v_mfma_f32_16x16x32_bf16 v[156:159], v[196:199], v[96:99], v[156:159]
    v_cvt_pk_bf16_f32 v132, v136, v137
    v_fma_f32 v140, v140, s45, -v248
    v_fma_f32 v141, v141, s45, -v248
    v_mfma_f32_16x16x32_bf16 v[172:175], v[196:199], v[100:103], v[172:175]
    ds_read_b64_tr_b16 v[204:205], v231 offset:0
    ds_read_b64_tr_b16 v[206:207], v231 offset:2048
    v_exp_f32 v140, v140
    v_mfma_f32_16x16x32_bf16 v[16:19], v[220:223], v[96:99], v[16:19]
    v_exp_f32 v141, v141
    v_cvt_pk_bf16_f32 v133, v138, v139
    v_fma_f32 v142, v142, s45, -v248
    v_fma_f32 v143, v143, s45, -v248
    v_mfma_f32_16x16x32_bf16 v[20:23], v[220:223], v[100:103], v[20:23]
    ds_read_b64_tr_b16 v[208:209], v232 offset:0
    ds_read_b64_tr_b16 v[210:211], v232 offset:2048
    v_exp_f32 v142, v142
    v_exp_f32 v143, v143
    v_cvt_pk_bf16_f32 v134, v140, v141
    v_cvt_pk_bf16_f32 v135, v142, v143
    s_waitcnt lgkmcnt(4)
    v_mfma_f32_16x16x32_bf16 v[144:147], v[200:203], v[104:107], v[144:147]
    v_mfma_f32_16x16x32_bf16 v[160:163], v[200:203], v[108:111], v[160:163]
    ds_read_b64_tr_b16 v[212:213], v233 offset:0
    ds_read_b64_tr_b16 v[214:215], v233 offset:2048
    s_waitcnt lgkmcnt(4)
    v_mfma_f32_16x16x32_bf16 v[148:151], v[204:207], v[104:107], v[148:151]
    v_mfma_f32_16x16x32_bf16 v[164:167], v[204:207], v[108:111], v[164:167]
    s_waitcnt lgkmcnt(2)
    v_mfma_f32_16x16x32_bf16 v[152:155], v[208:211], v[104:107], v[152:155]
    v_mfma_f32_16x16x32_bf16 v[168:171], v[208:211], v[108:111], v[168:171]
    ds_read_b64_tr_b16 v[192:193], v230 offset:16384
    ds_read_b64_tr_b16 v[194:195], v230 offset:18432
    s_waitcnt lgkmcnt(2)
    v_mfma_f32_16x16x32_bf16 v[156:159], v[212:215], v[104:107], v[156:159]
    v_mfma_f32_16x16x32_bf16 v[172:175], v[212:215], v[108:111], v[172:175]
    ds_read_b64_tr_b16 v[196:197], v231 offset:16384
    ds_read_b64_tr_b16 v[198:199], v231 offset:18432
    v_mfma_f32_16x16x32_bf16 v[16:19], v[220:223], v[104:107], v[16:19]
    v_mfma_f32_16x16x32_bf16 v[20:23], v[220:223], v[108:111], v[20:23]
    ds_read_b64_tr_b16 v[200:201], v232 offset:16384
    ds_read_b64_tr_b16 v[202:203], v232 offset:18432
    s_waitcnt lgkmcnt(4)
    v_mfma_f32_16x16x32_bf16 v[144:147], v[192:195], v[128:131], v[144:147]
    v_mfma_f32_16x16x32_bf16 v[160:163], v[192:195], v[132:135], v[160:163]
    ds_read_b64_tr_b16 v[204:205], v233 offset:16384
    ds_read_b64_tr_b16 v[206:207], v233 offset:18432
    s_waitcnt lgkmcnt(4)
    v_mfma_f32_16x16x32_bf16 v[148:151], v[196:199], v[128:131], v[148:151]
    v_mfma_f32_16x16x32_bf16 v[164:167], v[196:199], v[132:135], v[164:167]
    s_waitcnt lgkmcnt(2)
    v_mfma_f32_16x16x32_bf16 v[152:155], v[200:203], v[128:131], v[152:155]
    v_mfma_f32_16x16x32_bf16 v[168:171], v[200:203], v[132:135], v[168:171]
    s_waitcnt vmcnt(8)
    s_barrier
    s_add_u32 s47, s36, 131072
    v_add_u32 v230, s47, v226
    v_add_u32 v231, s47, v227
    v_add_u32 v232, s47, v228
    v_add_u32 v233, s47, v229
    ds_read_b64_tr_b16 v[208:209], v230 offset:4096
    ds_read_b64_tr_b16 v[210:211], v230 offset:6144
    s_waitcnt lgkmcnt(2)
    v_mfma_f32_16x16x32_bf16 v[156:159], v[204:207], v[128:131], v[156:159]
    v_mfma_f32_16x16x32_bf16 v[172:175], v[204:207], v[132:135], v[172:175]
    ds_read_b64_tr_b16 v[212:213], v231 offset:4096
    ds_read_b64_tr_b16 v[214:215], v231 offset:6144
    v_mfma_f32_16x16x32_bf16 v[16:19], v[220:223], v[128:131], v[16:19]
    v_mfma_f32_16x16x32_bf16 v[20:23], v[220:223], v[132:135], v[20:23]
    ds_read_b64_tr_b16 v[192:193], v232 offset:4096
    ds_read_b64_tr_b16 v[194:195], v232 offset:6144
    s_cmp_lg_u32 s54, 0
    s_cbranch_scc1 L_rare_h1
L_back_h1:
    s_waitcnt lgkmcnt(4)
    v_mfma_f32_16x16x32_bf16 v[176:179], v[208:211], v[64:67], v[176:179]
    v_mfma_f32_16x16x32_bf16 v[48:51], v[208:211], v[68:71], v[48:51]
    ds_read_b64_tr_b16 v[196:197], v233 offset:4096
    ds_read_b64_tr_b16 v[198:199], v233 offset:6144
    s_waitcnt lgkmcnt(4)
    v_mfma_f32_16x16x32_bf16 v[180:183], v[212:215], v[64:67], v[180:183]
    v_rcp_f32 v243, v16
    v_mfma_f32_16x16x32_bf16 v[52:55], v[212:215], v[68:71], v[52:55]
    ds_read_b64_tr_b16 v[200:201], v230 offset:8192
    ds_read_b64_tr_b16 v[202:203], v230 offset:10240
    v_rcp_f32 v244, v20
    s_waitcnt lgkmcnt(4)
    v_mfma_f32_16x16x32_bf16 v[184:187], v[192:195], v[64:67], v[184:187]
    v_mul_f32 v144, v243, v144
    v_mul_f32 v145, v243, v145
    v_mfma_f32_16x16x32_bf16 v[56:59], v[192:195], v[68:71], v[56:59]
    ds_read_b64_tr_b16 v[204:205], v231 offset:8192
    ds_read_b64_tr_b16 v[206:207], v231 offset:10240
    v_mul_f32 v146, v243, v146
    v_mul_f32 v147, v243, v147
    s_waitcnt lgkmcnt(4)
    v_mfma_f32_16x16x32_bf16 v[188:191], v[196:199], v[64:67], v[188:191]
    v_cvt_pk_bf16_f32 v112, v144, v145
    v_cvt_pk_bf16_f32 v113, v146, v147
    v_mfma_f32_16x16x32_bf16 v[60:63], v[196:199], v[68:71], v[60:63]
    ds_read_b64_tr_b16 v[208:209], v232 offset:8192
    ds_read_b64_tr_b16 v[210:211], v232 offset:10240
    ds_write_b64 v239, v[112:113] offset:32768
    v_mul_f32 v160, v244, v160
    s_waitcnt lgkmcnt(5)
    v_mfma_f32_16x16x32_bf16 v[176:179], v[200:203], v[72:75], v[176:179]
    v_mul_f32 v161, v244, v161
    v_mul_f32 v162, v244, v162
    v_mfma_f32_16x16x32_bf16 v[48:51], v[200:203], v[76:79], v[48:51]
    ds_read_b64_tr_b16 v[212:213], v233 offset:8192
    ds_read_b64_tr_b16 v[214:215], v233 offset:10240
    v_mul_f32 v163, v244, v163
    v_cvt_pk_bf16_f32 v114, v160, v161
    s_waitcnt lgkmcnt(5)
    v_mfma_f32_16x16x32_bf16 v[180:183], v[204:207], v[72:75], v[180:183]
    v_cvt_pk_bf16_f32 v115, v162, v163
    ds_write_b64 v239, v[114:115] offset:34816
    v_mfma_f32_16x16x32_bf16 v[52:55], v[204:207], v[76:79], v[52:55]
    ds_read_b64_tr_b16 v[192:193], v230 offset:12288
    ds_read_b64_tr_b16 v[194:195], v230 offset:14336
    v_xor_b32 v252, 32, v239
    v_mul_f32 v148, v243, v148
    s_waitcnt lgkmcnt(6)
    v_mfma_f32_16x16x32_bf16 v[184:187], v[208:211], v[72:75], v[184:187]
    v_mul_f32 v149, v243, v149
    v_mul_f32 v150, v243, v150
    v_mfma_f32_16x16x32_bf16 v[56:59], v[208:211], v[76:79], v[56:59]
    ds_read_b64_tr_b16 v[196:197], v231 offset:12288
    ds_read_b64_tr_b16 v[198:199], v231 offset:14336
    v_mul_f32 v151, v243, v151
    v_cvt_pk_bf16_f32 v116, v148, v149
    s_waitcnt lgkmcnt(5)
    v_mfma_f32_16x16x32_bf16 v[188:191], v[212:215], v[72:75], v[188:191]
    v_cvt_pk_bf16_f32 v117, v150, v151
    ds_write_b64 v252, v[116:117] offset:32768
    v_mfma_f32_16x16x32_bf16 v[60:63], v[212:215], v[76:79], v[60:63]
    ds_read_b64_tr_b16 v[200:201], v232 offset:12288
    ds_read_b64_tr_b16 v[202:203], v232 offset:14336
    v_mul_f32 v164, v244, v164
    s_waitcnt lgkmcnt(5)
    v_mfma_f32_16x16x32_bf16 v[176:179], v[192:195], v[96:99], v[176:179]
    v_mul_f32 v165, v244, v165
    v_mul_f32 v166, v244, v166
    v_mfma_f32_16x16x32_bf16 v[48:51], v[192:195], v[100:103], v[48:51]
    ds_read_b64_tr_b16 v[204:205], v233 offset:12288
    ds_read_b64_tr_b16 v[206:207], v233 offset:14336
    v_mul_f32 v167, v244, v167
    v_cvt_pk_bf16_f32 v118, v164, v165
    s_waitcnt lgkmcnt(5)
    v_mfma_f32_16x16x32_bf16 v[180:183], v[196:199], v[96:99], v[180:183]
    v_cvt_pk_bf16_f32 v119, v166, v167
    ds_write_b64 v252, v[118:119] offset:34816
    v_mfma_f32_16x16x32_bf16 v[52:55], v[196:199], v[100:103], v[52:55]
    ds_read_b64_tr_b16 v[208:209], v230 offset:0
    ds_read_b64_tr_b16 v[210:211], v230 offset:2048
    v_xor_b32 v253, 64, v239
    v_mul_f32 v152, v243, v152
    s_waitcnt lgkmcnt(5)
    v_mfma_f32_16x16x32_bf16 v[184:187], v[200:203], v[96:99], v[184:187]
    v_mul_f32 v153, v243, v153
    v_mul_f32 v154, v243, v154
    v_mfma_f32_16x16x32_bf16 v[56:59], v[200:203], v[100:103], v[56:59]
    ds_read_b64_tr_b16 v[212:213], v231 offset:0
    ds_read_b64_tr_b16 v[214:215], v231 offset:2048
    v_mul_f32 v155, v243, v155
    v_cvt_pk_bf16_f32 v120, v152, v153
    s_waitcnt lgkmcnt(5)
    v_mfma_f32_16x16x32_bf16 v[188:191], v[204:207], v[96:99], v[188:191]
    v_cvt_pk_bf16_f32 v121, v154, v155
    ds_write_b64 v253, v[120:121] offset:32768
    v_mfma_f32_16x16x32_bf16 v[60:63], v[204:207], v[100:103], v[60:63]
    ds_read_b64_tr_b16 v[192:193], v232 offset:0
    ds_read_b64_tr_b16 v[194:195], v232 offset:2048
    v_mul_f32 v168, v244, v168
    v_mul_f32 v169, v244, v169
    s_waitcnt lgkmcnt(5)
    v_mfma_f32_16x16x32_bf16 v[176:179], v[208:211], v[104:107], v[176:179]
    v_mul_f32 v170, v244, v170
    v_mul_f32 v171, v244, v171
    v_mfma_f32_16x16x32_bf16 v[48:51], v[208:211], v[108:111], v[48:51]
    ds_read_b64_tr_b16 v[196:197], v233 offset:0
    ds_read_b64_tr_b16 v[198:199], v233 offset:2048
    v_cvt_pk_bf16_f32 v122, v168, v169
    v_cvt_pk_bf16_f32 v123, v170, v171
    s_waitcnt lgkmcnt(5)
    v_mfma_f32_16x16x32_bf16 v[180:183], v[212:215], v[104:107], v[180:183]
    ds_write_b64 v253, v[122:123] offset:34816
    v_xor_b32 v252, 96, v239
    v_mfma_f32_16x16x32_bf16 v[52:55], v[212:215], v[108:111], v[52:55]
    ds_read_b64_tr_b16 v[200:201], v230 offset:16384
    ds_read_b64_tr_b16 v[202:203], v230 offset:18432
    v_mul_f32 v156, v243, v156
    v_mul_f32 v157, v243, v157
    s_waitcnt lgkmcnt(5)
    v_mfma_f32_16x16x32_bf16 v[184:187], v[192:195], v[104:107], v[184:187]
    v_mul_f32 v158, v243, v158
    v_mul_f32 v159, v243, v159
    v_mfma_f32_16x16x32_bf16 v[56:59], v[192:195], v[108:111], v[56:59]
    ds_read_b64_tr_b16 v[204:205], v231 offset:16384
    ds_read_b64_tr_b16 v[206:207], v231 offset:18432
    v_cvt_pk_bf16_f32 v124, v156, v157
    v_cvt_pk_bf16_f32 v125, v158, v159
    s_waitcnt lgkmcnt(5)
    v_mfma_f32_16x16x32_bf16 v[188:191], v[196:199], v[104:107], v[188:191]
    ds_write_b64 v252, v[124:125] offset:32768
    v_mul_f32 v172, v244, v172
    v_mfma_f32_16x16x32_bf16 v[60:63], v[196:199], v[108:111], v[60:63]
    ds_read_b64_tr_b16 v[208:209], v232 offset:16384
    ds_read_b64_tr_b16 v[210:211], v232 offset:18432
    v_mul_f32 v173, v244, v173
    v_mul_f32 v174, v244, v174
    s_waitcnt lgkmcnt(5)
    v_mfma_f32_16x16x32_bf16 v[176:179], v[200:203], v[128:131], v[176:179]
    v_mul_f32 v175, v244, v175
    v_cvt_pk_bf16_f32 v126, v172, v173
    v_mfma_f32_16x16x32_bf16 v[48:51], v[200:203], v[132:135], v[48:51]
    ds_read_b64_tr_b16 v[212:213], v233 offset:16384
    ds_read_b64_tr_b16 v[214:215], v233 offset:18432
    v_cvt_pk_bf16_f32 v127, v174, v175
    ds_write_b64 v252, v[126:127] offset:34816
    s_waitcnt lgkmcnt(6)
    v_mfma_f32_16x16x32_bf16 v[180:183], v[204:207], v[128:131], v[180:183]
    v_mfma_f32_16x16x32_bf16 v[52:55], v[204:207], v[132:135], v[52:55]
    s_waitcnt vmcnt(4)
    s_barrier
    v_add_u32 v230, 16384, v226
    v_add_u32 v231, 16384, v227
    v_add_u32 v232, 16384, v228
    v_add_u32 v233, 16384, v229
    ds_read_b64_tr_b16 v[192:193], v230 offset:0
    ds_read_b64_tr_b16 v[194:195], v230 offset:2048
    s_waitcnt lgkmcnt(5)
    v_mfma_f32_16x16x32_bf16 v[184:187], v[208:211], v[128:131], v[184:187]
    ds_read_b128 v[112:115], v240 offset:32768
    ds_read_b128 v[116:119], v240 offset:33792
    v_mfma_f32_16x16x32_bf16 v[56:59], v[208:211], v[132:135], v[56:59]
    ds_read_b64_tr_b16 v[196:197], v231 offset:0
    ds_read_b64_tr_b16 v[198:199], v231 offset:2048
    ds_read_b128 v[120:123], v240 offset:34816
    ds_read_b128 v[124:127], v240 offset:35840
    s_waitcnt lgkmcnt(9)
    v_mfma_f32_16x16x32_bf16 v[188:191], v[212:215], v[128:131], v[188:191]
    s_waitcnt lgkmcnt(5)
    buffer_store_dwordx4 v[112:115], v238, s[28:31], s32 offen offset:0 nt
    s_waitcnt lgkmcnt(4)
    buffer_store_dwordx4 v[116:119], v238, s[28:31], s32 offen offset:3072 nt
    v_mfma_f32_16x16x32_bf16 v[60:63], v[212:215], v[132:135], v[60:63]
    ds_read_b64_tr_b16 v[200:201], v232 offset:0
    ds_read_b64_tr_b16 v[202:203], v232 offset:2048
    s_waitcnt lgkmcnt(3)
    buffer_store_dwordx4 v[120:123], v238, s[28:31], s33 offen offset:0 nt
    s_waitcnt lgkmcnt(2)
    buffer_store_dwordx4 v[124:127], v238, s[28:31], s33 offen offset:3072 nt
    v_mfma_f32_16x16x32_bf16 v[144:147], v[192:195], v[0:3], 0
    v_mfma_f32_16x16x32_bf16 v[160:163], v[192:195], v[4:7], 0
    ds_read_b64_tr_b16 v[204:205], v233 offset:0
    ds_read_b64_tr_b16 v[206:207], v233 offset:2048
    v_mfma_f32_16x16x32_bf16 v[148:151], v[196:199], v[0:3], 0
    v_mfma_f32_16x16x32_bf16 v[164:167], v[196:199], v[4:7], 0
    ds_read_b64_tr_b16 v[208:209], v230 offset:4096
    ds_read_b64_tr_b16 v[210:211], v230 offset:6144
    s_waitcnt lgkmcnt(4)
    v_mfma_f32_16x16x32_bf16 v[152:155], v[200:203], v[0:3], 0
    v_mul_f32 v176, v243, v176
    v_mul_f32 v177, v243, v177
    v_mul_f32 v178, v243, v178
    v_mfma_f32_16x16x32_bf16 v[168:171], v[200:203], v[4:7], 0
    ds_read_b64_tr_b16 v[212:213], v231 offset:4096
    ds_read_b64_tr_b16 v[214:215], v231 offset:6144
    v_mul_f32 v179, v243, v179
    v_cvt_pk_bf16_f32 v112, v176, v177
    s_waitcnt lgkmcnt(4)
    v_mfma_f32_16x16x32_bf16 v[156:159], v[204:207], v[0:3], 0
    v_cvt_pk_bf16_f32 v113, v178, v179
    ds_write_b64 v239, v[112:113] offset:32768
    v_mul_f32 v48, v244, v48
    v_mfma_f32_16x16x32_bf16 v[172:175], v[204:207], v[4:7], 0
    ds_read_b64_tr_b16 v[192:193], v232 offset:4096
    ds_read_b64_tr_b16 v[194:195], v232 offset:6144
    v_mul_f32 v49, v244, v49
    v_mul_f32 v50, v244, v50
    s_waitcnt lgkmcnt(5)
    v_mfma_f32_16x16x32_bf16 v[144:147], v[208:211], v[8:11], v[144:147]
    v_mul_f32 v51, v244, v51
    v_cvt_pk_bf16_f32 v114, v48, v49
    v_cvt_pk_bf16_f32 v115, v50, v51
    v_mfma_f32_16x16x32_bf16 v[160:163], v[208:211], v[12:15], v[160:163]
    ds_read_b64_tr_b16 v[196:197], v233 offset:4096
    ds_read_b64_tr_b16 v[198:199], v233 offset:6144
    ds_write_b64 v239, v[114:115] offset:34816
    v_xor_b32 v252, 32, v239
    s_waitcnt lgkmcnt(6)
    v_mfma_f32_16x16x32_bf16 v[148:151], v[212:215], v[8:11], v[148:151]
    v_mul_f32 v180, v243, v180
    v_mul_f32 v181, v243, v181
    v_mul_f32 v182, v243, v182
    v_mfma_f32_16x16x32_bf16 v[164:167], v[212:215], v[12:15], v[164:167]
    ds_read_b64_tr_b16 v[200:201], v230 offset:8192
    ds_read_b64_tr_b16 v[202:203], v230 offset:10240
    v_mul_f32 v183, v243, v183
    v_cvt_pk_bf16_f32 v116, v180, v181
    s_waitcnt lgkmcnt(5)
    v_mfma_f32_16x16x32_bf16 v[152:155], v[192:195], v[8:11], v[152:155]
    v_cvt_pk_bf16_f32 v117, v182, v183
    ds_write_b64 v252, v[116:117] offset:32768
    v_mul_f32 v52, v244, v52
    v_mfma_f32_16x16x32_bf16 v[168:171], v[192:195], v[12:15], v[168:171]
    ds_read_b64_tr_b16 v[204:205], v231 offset:8192
    ds_read_b64_tr_b16 v[206:207], v231 offset:10240
    v_mul_f32 v53, v244, v53
    v_mul_f32 v54, v244, v54
    s_waitcnt lgkmcnt(6)
    v_mfma_f32_16x16x32_bf16 v[156:159], v[196:199], v[8:11], v[156:159]
    v_mul_f32 v55, v244, v55
    v_cvt_pk_bf16_f32 v118, v52, v53
    v_cvt_pk_bf16_f32 v119, v54, v55
    v_mfma_f32_16x16x32_bf16 v[172:175], v[196:199], v[12:15], v[172:175]
    ds_read_b64_tr_b16 v[208:209], v232 offset:8192
    ds_read_b64_tr_b16 v[210:211], v232 offset:10240
    ds_write_b64 v252, v[118:119] offset:34816
    v_xor_b32 v253, 64, v239
    v_mul_f32 v184, v243, v184
    s_waitcnt lgkmcnt(6)
    v_mfma_f32_16x16x32_bf16 v[144:147], v[200:203], v[32:35], v[144:147]
    v_mul_f32 v185, v243, v185
    v_mul_f32 v186, v243, v186
    v_mul_f32 v187, v243, v187
    v_mfma_f32_16x16x32_bf16 v[160:163], v[200:203], v[36:39], v[160:163]
    ds_read_b64_tr_b16 v[212:213], v233 offset:8192
    ds_read_b64_tr_b16 v[214:215], v233 offset:10240
    v_cvt_pk_bf16_f32 v120, v184, v185
    v_cvt_pk_bf16_f32 v121, v186, v187
    s_waitcnt lgkmcnt(5)
    v_mfma_f32_16x16x32_bf16 v[148:151], v[204:207], v[32:35], v[148:151]
    ds_write_b64 v253, v[120:121] offset:32768
    v_mul_f32 v56, v244, v56
    v_mul_f32 v57, v244, v57
    v_mfma_f32_16x16x32_bf16 v[164:167], v[204:207], v[36:39], v[164:167]
    ds_read_b64_tr_b16 v[192:193], v230 offset:12288
    ds_read_b64_tr_b16 v[194:195], v230 offset:14336
    v_mul_f32 v58, v244, v58
    v_mul_f32 v59, v244, v59
    s_waitcnt lgkmcnt(6)
    v_mfma_f32_16x16x32_bf16 v[152:155], v[208:211], v[32:35], v[152:155]
    v_cvt_pk_bf16_f32 v122, v56, v57
    v_cvt_pk_bf16_f32 v123, v58, v59
    ds_write_b64 v253, v[122:123] offset:34816
    v_mfma_f32_16x16x32_bf16 v[168:171], v[208:211], v[36:39], v[168:171]
    ds_read_b64_tr_b16 v[196:197], v231 offset:12288
    ds_read_b64_tr_b16 v[198:199], v231 offset:14336
    v_xor_b32 v252, 96, v239
    v_mul_f32 v188, v243, v188
    s_waitcnt lgkmcnt(6)
    v_mfma_f32_16x16x32_bf16 v[156:159], v[212:215], v[32:35], v[156:159]
    v_mul_f32 v189, v243, v189
    v_mul_f32 v190, v243, v190
    v_mul_f32 v191, v243, v191
    v_mfma_f32_16x16x32_bf16 v[172:175], v[212:215], v[36:39], v[172:175]
    ds_read_b64_tr_b16 v[200:201], v232 offset:12288
    ds_read_b64_tr_b16 v[202:203], v232 offset:14336
    v_cvt_pk_bf16_f32 v124, v188, v189
    v_cvt_pk_bf16_f32 v125, v190, v191
    s_waitcnt lgkmcnt(5)
    v_mfma_f32_16x16x32_bf16 v[144:147], v[192:195], v[40:43], v[144:147]
    ds_write_b64 v252, v[124:125] offset:32768
    v_mul_f32 v60, v244, v60
    v_mul_f32 v61, v244, v61
    v_mfma_f32_16x16x32_bf16 v[160:163], v[192:195], v[44:47], v[160:163]
    ds_read_b64_tr_b16 v[204:205], v233 offset:12288
    ds_read_b64_tr_b16 v[206:207], v233 offset:14336
    v_mul_f32 v62, v244, v62
    v_mul_f32 v63, v244, v63
    s_waitcnt lgkmcnt(5)
    v_mfma_f32_16x16x32_bf16 v[148:151], v[196:199], v[40:43], v[148:151]
    v_cvt_pk_bf16_f32 v126, v60, v61
    v_mfma_f32_16x16x32_bf16 v[164:167], v[196:199], v[44:47], v[164:167]
    s_waitcnt vmcnt(4)
    s_barrier
    s_add_u32 s47, s36, 32768
    v_add_u32 v230, s47, v226
    v_add_u32 v231, s47, v227
    v_add_u32 v232, s47, v228
    v_add_u32 v233, s47, v229
    ds_read_b64_tr_b16 v[208:209], v230 offset:4096
    ds_read_b64_tr_b16 v[210:211], v230 offset:6144
    s_waitcnt lgkmcnt(5)
    v_mfma_f32_16x16x32_bf16 v[152:155], v[200:203], v[40:43], v[152:155]
    v_cvt_pk_bf16_f32 v127, v62, v63
    ds_write_b64 v252, v[126:127] offset:34816
    ds_read_b128 v[112:115], v240 offset:32768
    v_mfma_f32_16x16x32_bf16 v[168:171], v[200:203], v[44:47], v[168:171]
    ds_read_b64_tr_b16 v[212:213], v231 offset:4096
    ds_read_b64_tr_b16 v[214:215], v231 offset:6144
    ds_read_b128 v[116:119], v240 offset:33792
    ds_read_b128 v[120:123], v240 offset:34816
    s_waitcnt lgkmcnt(8)
    v_mfma_f32_16x16x32_bf16 v[156:159], v[204:207], v[40:43], v[156:159]
    ds_read_b128 v[124:127], v240 offset:35840
    s_waitcnt lgkmcnt(5)
    buffer_store_dwordx4 v[112:115], v238, s[28:31], s32 offen offset:128 nt
    s_waitcnt lgkmcnt(2)
    buffer_store_dwordx4 v[116:119], v238, s[28:31], s32 offen offset:3200 nt
    v_mfma_f32_16x16x32_bf16 v[172:175], v[204:207], v[44:47], v[172:175]
    ds_read_b64_tr_b16 v[192:193], v232 offset:4096
    ds_read_b64_tr_b16 v[194:195], v232 offset:6144
    s_waitcnt lgkmcnt(3)
    buffer_store_dwordx4 v[120:123], v238, s[28:31], s33 offen offset:128 nt
    s_waitcnt lgkmcnt(2)
    buffer_store_dwordx4 v[124:127], v238, s[28:31], s33 offen offset:3200 nt
    s_cmp_lg_u32 s54, 0
    s_cbranch_scc1 L_rare_h2
L_back_h2:
    v_mfma_f32_16x16x32_bf16 v[144:147], v[208:211], v[64:67], v[144:147]
    v_mfma_f32_16x16x32_bf16 v[160:163], v[208:211], v[68:71], v[160:163]
    ds_read_b64_tr_b16 v[196:197], v233 offset:4096
    ds_read_b64_tr_b16 v[198:199], v233 offset:6144
    v_mfma_f32_16x16x32_bf16 v[148:151], v[212:215], v[64:67], v[148:151]
    v_mfma_f32_16x16x32_bf16 v[164:167], v[212:215], v[68:71], v[164:167]
    ds_read_b64_tr_b16 v[200:201], v230 offset:8192
    ds_read_b64_tr_b16 v[202:203], v230 offset:10240
    s_waitcnt lgkmcnt(4)
    v_mfma_f32_16x16x32_bf16 v[152:155], v[192:195], v[64:67], v[152:155]
    v_mfma_f32_16x16x32_bf16 v[168:171], v[192:195], v[68:71], v[168:171]
    ds_read_b64_tr_b16 v[204:205], v231 offset:8192
    ds_read_b64_tr_b16 v[206:207], v231 offset:10240
    s_waitcnt lgkmcnt(4)
    v_mfma_f32_16x16x32_bf16 v[156:159], v[196:199], v[64:67], v[156:159]
    v_mfma_f32_16x16x32_bf16 v[172:175], v[196:199], v[68:71], v[172:175]
    ds_read_b64_tr_b16 v[208:209], v232 offset:8192
    ds_read_b64_tr_b16 v[210:211], v232 offset:10240
    s_waitcnt lgkmcnt(4)
    v_mfma_f32_16x16x32_bf16 v[144:147], v[200:203], v[72:75], v[144:147]
    v_mfma_f32_16x16x32_bf16 v[160:163], v[200:203], v[76:79], v[160:163]
    ds_read_b64_tr_b16 v[212:213], v233 offset:8192
    ds_read_b64_tr_b16 v[214:215], v233 offset:10240
    s_waitcnt lgkmcnt(4)
    v_mfma_f32_16x16x32_bf16 v[148:151], v[204:207], v[72:75], v[148:151]
    v_mfma_f32_16x16x32_bf16 v[164:167], v[204:207], v[76:79], v[164:167]
    ds_read_b64_tr_b16 v[192:193], v230 offset:12288
    ds_read_b64_tr_b16 v[194:195], v230 offset:14336
    s_waitcnt lgkmcnt(4)
    v_mfma_f32_16x16x32_bf16 v[152:155], v[208:211], v[72:75], v[152:155]
    v_mfma_f32_16x16x32_bf16 v[168:171], v[208:211], v[76:79], v[168:171]
    ds_read_b64_tr_b16 v[196:197], v231 offset:12288
    ds_read_b64_tr_b16 v[198:199], v231 offset:14336
    s_waitcnt lgkmcnt(4)
    v_mfma_f32_16x16x32_bf16 v[156:159], v[212:215], v[72:75], v[156:159]
    v_mfma_f32_16x16x32_bf16 v[172:175], v[212:215], v[76:79], v[172:175]
    ds_read_b64_tr_b16 v[200:201], v232 offset:12288
    ds_read_b64_tr_b16 v[202:203], v232 offset:14336
    s_waitcnt lgkmcnt(4)
    v_mfma_f32_16x16x32_bf16 v[144:147], v[192:195], v[96:99], v[144:147]
    v_mfma_f32_16x16x32_bf16 v[160:163], v[192:195], v[100:103], v[160:163]
    ds_read_b64_tr_b16 v[204:205], v233 offset:12288
    ds_read_b64_tr_b16 v[206:207], v233 offset:14336
    s_waitcnt lgkmcnt(4)
    v_mfma_f32_16x16x32_bf16 v[148:151], v[196:199], v[96:99], v[148:151]
    v_mfma_f32_16x16x32_bf16 v[164:167], v[196:199], v[100:103], v[164:167]
    ds_read_b64_tr_b16 v[208:209], v230 offset:0
    ds_read_b64_tr_b16 v[210:211], v230 offset:2048
    s_waitcnt lgkmcnt(4)
    v_mfma_f32_16x16x32_bf16 v[152:155], v[200:203], v[96:99], v[152:155]
    v_mfma_f32_16x16x32_bf16 v[168:171], v[200:203], v[100:103], v[168:171]
    ds_read_b64_tr_b16 v[212:213], v231 offset:0
    ds_read_b64_tr_b16 v[214:215], v231 offset:2048
    s_waitcnt lgkmcnt(4)
    v_mfma_f32_16x16x32_bf16 v[156:159], v[204:207], v[96:99], v[156:159]
    v_mfma_f32_16x16x32_bf16 v[172:175], v[204:207], v[100:103], v[172:175]
    ds_read_b64_tr_b16 v[192:193], v232 offset:0
    ds_read_b64_tr_b16 v[194:195], v232 offset:2048
    s_waitcnt lgkmcnt(4)
    v_mfma_f32_16x16x32_bf16 v[144:147], v[208:211], v[104:107], v[144:147]
    v_mfma_f32_16x16x32_bf16 v[160:163], v[208:211], v[108:111], v[160:163]
    ds_read_b64_tr_b16 v[196:197], v233 offset:0
    ds_read_b64_tr_b16 v[198:199], v233 offset:2048
    s_waitcnt lgkmcnt(4)
    v_mfma_f32_16x16x32_bf16 v[148:151], v[212:215], v[104:107], v[148:151]
    v_mfma_f32_16x16x32_bf16 v[164:167], v[212:215], v[108:111], v[164:167]
    ds_read_b64_tr_b16 v[200:201], v230 offset:16384
    ds_read_b64_tr_b16 v[202:203], v230 offset:18432
    s_waitcnt lgkmcnt(4)
    v_mfma_f32_16x16x32_bf16 v[152:155], v[192:195], v[104:107], v[152:155]
    v_mfma_f32_16x16x32_bf16 v[168:171], v[192:195], v[108:111], v[168:171]
    ds_read_b64_tr_b16 v[204:205], v231 offset:16384
    ds_read_b64_tr_b16 v[206:207], v231 offset:18432
    s_waitcnt lgkmcnt(4)
    v_mfma_f32_16x16x32_bf16 v[156:159], v[196:199], v[104:107], v[156:159]
    v_mfma_f32_16x16x32_bf16 v[172:175], v[196:199], v[108:111], v[172:175]
    ds_read_b64_tr_b16 v[208:209], v232 offset:16384
    ds_read_b64_tr_b16 v[210:211], v232 offset:18432
    s_waitcnt lgkmcnt(4)
    v_mfma_f32_16x16x32_bf16 v[144:147], v[200:203], v[128:131], v[144:147]
    v_mfma_f32_16x16x32_bf16 v[160:163], v[200:203], v[132:135], v[160:163]
    ds_read_b64_tr_b16 v[212:213], v233 offset:16384
    ds_read_b64_tr_b16 v[214:215], v233 offset:18432
    s_waitcnt lgkmcnt(4)
    v_mfma_f32_16x16x32_bf16 v[148:151], v[204:207], v[128:131], v[148:151]
    v_mfma_f32_16x16x32_bf16 v[164:167], v[204:207], v[132:135], v[164:167]
    s_waitcnt lgkmcnt(2)
    v_mfma_f32_16x16x32_bf16 v[152:155], v[208:211], v[128:131], v[152:155]
    v_mfma_f32_16x16x32_bf16 v[168:171], v[208:211], v[132:135], v[168:171]
    s_waitcnt lgkmcnt(0)
    v_mfma_f32_16x16x32_bf16 v[156:159], v[212:215], v[128:131], v[156:159]
    v_mfma_f32_16x16x32_bf16 v[172:175], v[212:215], v[132:135], v[172:175]
    v_mul_f32 v144, v243, v144
    v_mul_f32 v145, v243, v145
    v_mul_f32 v146, v243, v146
    v_mul_f32 v147, v243, v147
    v_cvt_pk_bf16_f32 v112, v144, v145
    v_cvt_pk_bf16_f32 v113, v146, v147
    ds_write_b64 v239, v[112:113] offset:32768
    v_mul_f32 v160, v244, v160
    v_mul_f32 v161, v244, v161
    v_mul_f32 v162, v244, v162
    v_mul_f32 v163, v244, v163
    v_cvt_pk_bf16_f32 v114, v160, v161
    v_cvt_pk_bf16_f32 v115, v162, v163
    ds_write_b64 v239, v[114:115] offset:34816
    v_xor_b32 v252, 32, v239
    v_mul_f32 v148, v243, v148
    v_mul_f32 v149, v243, v149
    v_mul_f32 v150, v243, v150
    v_mul_f32 v151, v243, v151
    v_cvt_pk_bf16_f32 v116, v148, v149
    v_cvt_pk_bf16_f32 v117, v150, v151
    ds_write_b64 v252, v[116:117] offset:32768
    v_mul_f32 v164, v244, v164
    v_mul_f32 v165, v244, v165
    v_mul_f32 v166, v244, v166
    v_mul_f32 v167, v244, v167
    v_cvt_pk_bf16_f32 v118, v164, v165
    v_cvt_pk_bf16_f32 v119, v166, v167
    ds_write_b64 v252, v[118:119] offset:34816
    v_xor_b32 v253, 64, v239
    v_mul_f32 v152, v243, v152
    v_mul_f32 v153, v243, v153
    v_mul_f32 v154, v243, v154
    v_mul_f32 v155, v243, v155
    v_cvt_pk_bf16_f32 v120, v152, v153
    v_cvt_pk_bf16_f32 v121, v154, v155
    ds_write_b64 v253, v[120:121] offset:32768
    v_mul_f32 v168, v244, v168
    v_mul_f32 v169, v244, v169
    v_mul_f32 v170, v244, v170
    v_mul_f32 v171, v244, v171
    v_cvt_pk_bf16_f32 v122, v168, v169
    v_cvt_pk_bf16_f32 v123, v170, v171
    ds_write_b64 v253, v[122:123] offset:34816
    v_xor_b32 v252, 96, v239
    v_mul_f32 v156, v243, v156
    v_mul_f32 v157, v243, v157
    v_mul_f32 v158, v243, v158
    v_mul_f32 v159, v243, v159
    v_cvt_pk_bf16_f32 v124, v156, v157
    v_cvt_pk_bf16_f32 v125, v158, v159
    ds_write_b64 v252, v[124:125] offset:32768
    v_mul_f32 v172, v244, v172
    v_mul_f32 v173, v244, v173
    v_mul_f32 v174, v244, v174
    v_mul_f32 v175, v244, v175
    v_cvt_pk_bf16_f32 v126, v172, v173
    v_cvt_pk_bf16_f32 v127, v174, v175
    ds_write_b64 v252, v[126:127] offset:34816
    ds_read_b128 v[112:115], v240 offset:32768
    ds_read_b128 v[116:119], v240 offset:33792
    ds_read_b128 v[120:123], v240 offset:34816
    ds_read_b128 v[124:127], v240 offset:35840
    s_waitcnt lgkmcnt(3)
    buffer_store_dwordx4 v[112:115], v238, s[28:31], s32 offen offset:256 nt
    s_waitcnt lgkmcnt(2)
    buffer_store_dwordx4 v[116:119], v238, s[28:31], s32 offen offset:3328 nt
    s_waitcnt lgkmcnt(1)
    buffer_store_dwordx4 v[120:123], v238, s[28:31], s33 offen offset:256 nt
    s_waitcnt lgkmcnt(0)
    buffer_store_dwordx4 v[124:127], v238, s[28:31], s33 offen offset:3328 nt
    s_endpgm
L_end:
    s_endpgm
L_rare_ml:
    v_max_f32 v241, v241, v243
    v_mul_f32 v247, s45, v241
    v_sub_f32 v249, v245, v247
    v_exp_f32 v249, v249
    v_max_f32 v242, v242, v244
    v_mul_f32 v248, s45, v242
    v_sub_f32 v250, v246, v248
    v_exp_f32 v250, v250
    s_mov_b32 s54, 1
    s_nop 1
    s_branch L_back_ml
L_rare_l0:
    s_nop 15
    v_mul_f32 v144, v249, v144
    v_mul_f32 v145, v249, v145
    v_mul_f32 v146, v249, v146
    v_mul_f32 v147, v249, v147
    v_mul_f32 v148, v249, v148
    v_mul_f32 v149, v249, v149
    v_mul_f32 v150, v249, v150
    v_mul_f32 v151, v249, v151
    v_mul_f32 v152, v249, v152
    v_mul_f32 v153, v249, v153
    v_mul_f32 v154, v249, v154
    v_mul_f32 v155, v249, v155
    v_mul_f32 v156, v249, v156
    v_mul_f32 v157, v249, v157
    v_mul_f32 v158, v249, v158
    v_mul_f32 v159, v249, v159
    v_mul_f32 v160, v250, v160
    v_mul_f32 v161, v250, v161
    v_mul_f32 v162, v250, v162
    v_mul_f32 v163, v250, v163
    v_mul_f32 v164, v250, v164
    v_mul_f32 v165, v250, v165
    v_mul_f32 v166, v250, v166
    v_mul_f32 v167, v250, v167
    v_mul_f32 v168, v250, v168
    v_mul_f32 v169, v250, v169
    v_mul_f32 v170, v250, v170
    v_mul_f32 v171, v250, v171
    v_mul_f32 v172, v250, v172
    v_mul_f32 v173, v250, v173
    v_mul_f32 v174, v250, v174
    v_mul_f32 v175, v250, v175
    v_mul_f32 v16, v249, v16
    v_mul_f32 v20, v250, v20
    s_nop 1
    s_branch L_back_l0
L_rare_l1:
    s_nop 15
    v_mul_f32 v176, v249, v176
    v_mul_f32 v177, v249, v177
    v_mul_f32 v178, v249, v178
    v_mul_f32 v179, v249, v179
    v_mul_f32 v180, v249, v180
    v_mul_f32 v181, v249, v181
    v_mul_f32 v182, v249, v182
    v_mul_f32 v183, v249, v183
    v_mul_f32 v184, v249, v184
    v_mul_f32 v185, v249, v185
    v_mul_f32 v186, v249, v186
    v_mul_f32 v187, v249, v187
    v_mul_f32 v188, v249, v188
    v_mul_f32 v189, v249, v189
    v_mul_f32 v190, v249, v190
    v_mul_f32 v191, v249, v191
    v_mul_f32 v48, v250, v48
    v_mul_f32 v49, v250, v49
    v_mul_f32 v50, v250, v50
    v_mul_f32 v51, v250, v51
    v_mul_f32 v52, v250, v52
    v_mul_f32 v53, v250, v53
    v_mul_f32 v54, v250, v54
    v_mul_f32 v55, v250, v55
    v_mul_f32 v56, v250, v56
    v_mul_f32 v57, v250, v57
    v_mul_f32 v58, v250, v58
    v_mul_f32 v59, v250, v59
    v_mul_f32 v60, v250, v60
    v_mul_f32 v61, v250, v61
    v_mul_f32 v62, v250, v62
    v_mul_f32 v63, v250, v63
    s_nop 1
    s_branch L_back_l1
L_rare_l2:
    s_nop 15
    v_mul_f32 v144, v249, v144
    v_mul_f32 v145, v249, v145
    v_mul_f32 v146, v249, v146
    v_mul_f32 v147, v249, v147
    v_mul_f32 v148, v249, v148
    v_mul_f32 v149, v249, v149
    v_mul_f32 v150, v249, v150
    v_mul_f32 v151, v249, v151
    v_mul_f32 v152, v249, v152
    v_mul_f32 v153, v249, v153
    v_mul_f32 v154, v249, v154
    v_mul_f32 v155, v249, v155
    v_mul_f32 v156, v249, v156
    v_mul_f32 v157, v249, v157
    v_mul_f32 v158, v249, v158
    v_mul_f32 v159, v249, v159
    v_mul_f32 v160, v250, v160
    v_mul_f32 v161, v250, v161
    v_mul_f32 v162, v250, v162
    v_mul_f32 v163, v250, v163
    v_mul_f32 v164, v250, v164
    v_mul_f32 v165, v250, v165
    v_mul_f32 v166, v250, v166
    v_mul_f32 v167, v250, v167
    v_mul_f32 v168, v250, v168
    v_mul_f32 v169, v250, v169
    v_mul_f32 v170, v250, v170
    v_mul_f32 v171, v250, v171
    v_mul_f32 v172, v250, v172
    v_mul_f32 v173, v250, v173
    v_mul_f32 v174, v250, v174
    v_mul_f32 v175, v250, v175
    s_nop 1
    s_branch L_back_l2
L_rare_mh:
    v_max_f32 v241, v241, v243
    v_mul_f32 v247, s45, v241
    v_sub_f32 v249, v245, v247
    v_exp_f32 v249, v249
    v_max_f32 v242, v242, v244
    v_mul_f32 v248, s45, v242
    v_sub_f32 v250, v246, v248
    v_exp_f32 v250, v250
    s_mov_b32 s54, 1
    s_nop 1
    s_branch L_back_mh
L_rare_h0:
    s_nop 15
    v_mul_f32 v144, v249, v144
    v_mul_f32 v145, v249, v145
    v_mul_f32 v146, v249, v146
    v_mul_f32 v147, v249, v147
    v_mul_f32 v148, v249, v148
    v_mul_f32 v149, v249, v149
    v_mul_f32 v150, v249, v150
    v_mul_f32 v151, v249, v151
    v_mul_f32 v152, v249, v152
    v_mul_f32 v153, v249, v153
    v_mul_f32 v154, v249, v154
    v_mul_f32 v155, v249, v155
    v_mul_f32 v156, v249, v156
    v_mul_f32 v157, v249, v157
    v_mul_f32 v158, v249, v158
    v_mul_f32 v159, v249, v159
    v_mul_f32 v160, v250, v160
    v_mul_f32 v161, v250, v161
    v_mul_f32 v162, v250, v162
    v_mul_f32 v163, v250, v163
    v_mul_f32 v164, v250, v164
    v_mul_f32 v165, v250, v165
    v_mul_f32 v166, v250, v166
    v_mul_f32 v167, v250, v167
    v_mul_f32 v168, v250, v168
    v_mul_f32 v169, v250, v169
    v_mul_f32 v170, v250, v170
    v_mul_f32 v171, v250, v171
    v_mul_f32 v172, v250, v172
    v_mul_f32 v173, v250, v173
    v_mul_f32 v174, v250, v174
    v_mul_f32 v175, v250, v175
    v_mul_f32 v16, v249, v16
    v_mul_f32 v20, v250, v20
    s_nop 1
    s_branch L_back_h0
L_rare_h1:
    s_nop 15
    v_mul_f32 v176, v249, v176
    v_mul_f32 v177, v249, v177
    v_mul_f32 v178, v249, v178
    v_mul_f32 v179, v249, v179
    v_mul_f32 v180, v249, v180
    v_mul_f32 v181, v249, v181
    v_mul_f32 v182, v249, v182
    v_mul_f32 v183, v249, v183
    v_mul_f32 v184, v249, v184
    v_mul_f32 v185, v249, v185
    v_mul_f32 v186, v249, v186
    v_mul_f32 v187, v249, v187
    v_mul_f32 v188, v249, v188
    v_mul_f32 v189, v249, v189
    v_mul_f32 v190, v249, v190
    v_mul_f32 v191, v249, v191
    v_mul_f32 v48, v250, v48
    v_mul_f32 v49, v250, v49
    v_mul_f32 v50, v250, v50
    v_mul_f32 v51, v250, v51
    v_mul_f32 v52, v250, v52
    v_mul_f32 v53, v250, v53
    v_mul_f32 v54, v250, v54
    v_mul_f32 v55, v250, v55
    v_mul_f32 v56, v250, v56
    v_mul_f32 v57, v250, v57
    v_mul_f32 v58, v250, v58
    v_mul_f32 v59, v250, v59
    v_mul_f32 v60, v250, v60
    v_mul_f32 v61, v250, v61
    v_mul_f32 v62, v250, v62
    v_mul_f32 v63, v250, v63
    s_nop 1
    s_branch L_back_h1
L_rare_h2:
    s_nop 15
    v_mul_f32 v144, v249, v144
    v_mul_f32 v145, v249, v145
    v_mul_f32 v146, v249, v146
    v_mul_f32 v147, v249, v147
    v_mul_f32 v148, v249, v148
    v_mul_f32 v149, v249, v149
    v_mul_f32 v150, v249, v150
    v_mul_f32 v151, v249, v151
    v_mul_f32 v152, v249, v152
    v_mul_f32 v153, v249, v153
    v_mul_f32 v154, v249, v154
    v_mul_f32 v155, v249, v155
    v_mul_f32 v156, v249, v156
    v_mul_f32 v157, v249, v157
    v_mul_f32 v158, v249, v158
    v_mul_f32 v159, v249, v159
    v_mul_f32 v160, v250, v160
    v_mul_f32 v161, v250, v161
    v_mul_f32 v162, v250, v162
    v_mul_f32 v163, v250, v163
    v_mul_f32 v164, v250, v164
    v_mul_f32 v165, v250, v165
    v_mul_f32 v166, v250, v166
    v_mul_f32 v167, v250, v167
    v_mul_f32 v168, v250, v168
    v_mul_f32 v169, v250, v169
    v_mul_f32 v170, v250, v170
    v_mul_f32 v171, v250, v171
    v_mul_f32 v172, v250, v172
    v_mul_f32 v173, v250, v173
    v_mul_f32 v174, v250, v174
    v_mul_f32 v175, v250, v175
    s_nop 1
    s_branch L_back_h2
.section .rodata,"a"
.p2align 6
.amdhsa_kernel standalone__sliding_window_attn__prompt_kernel
  .amdhsa_next_free_vgpr 256
  .amdhsa_next_free_sgpr 64
  .amdhsa_accum_offset 256
  .amdhsa_group_segment_fixed_size 0
  .amdhsa_kernarg_size 56
  .amdhsa_user_sgpr_count 2
  .amdhsa_user_sgpr_kernarg_segment_ptr 1
  .amdhsa_system_sgpr_workgroup_id_x 1
.end_amdhsa_kernel
```
